```python
import torch

def _softmax(x, axis=-1):
    return torch.softmax(x, dim=axis)

def _gelu(x):
    return torch.nn.functional.gelu(x, approximate='tanh')

def _silu(x):
    return torch.nn.functional.silu(x)

def _sigmoid(x):
    return torch.sigmoid(x)

def _layernorm(x, axis=-1, eps=1e-05):
    m = x.mean(dim=axis, keepdim=True)
    v = x.var(dim=axis, keepdim=True, unbiased=False)
    return (x - m) / torch.sqrt(v + eps)

def _scatter_add(tgt, idx, src, axis=0):
    return tgt.clone().index_add_(axis, idx, src)

def _segment_sum(src, seg, n):
    out = torch.zeros((n,) + src.shape[1:], dtype=src.dtype)
    return out.index_add_(0, seg, src)

def _pad(x, pw):
    flat = tuple((v for pair in reversed(pw) for v in pair))
    return torch.nn.functional.pad(x, flat)
kernel_name = 'adaLN_cond__spectral_fnet__geglu_ffn__prompt'

def setup_inputs():

    _w = lambda a: (lambda t: t.to(torch.bfloat16) if t.is_floating_point() else t)(torch.as_tensor(a))

    def _A_setup():
        B, S, D = (1, 2048, 512)
        ns = torch.arange(S)[:, None] * torch.arange(S)[None, :]
        nd = torch.arange(D)[:, None] * torch.arange(D)[None, :]
        Ws_re = torch.cos(-2.0 * torch.pi * ns / S).to(float)
        Ws_im = torch.sin(-2.0 * torch.pi * ns / S).to(float)
        Wd_re = torch.cos(-2.0 * torch.pi * nd / D).to(float)
        Wd_im = torch.sin(-2.0 * torch.pi * nd / D).to(float)
        return {'x': _w((lambda *s: torch.randn(*s, dtype=torch.bfloat16) * 0.05)(B, S, D)), 'dft_seq_re': _w(Ws_re), 'dft_seq_im': _w(Ws_im), 'dft_hid_re': _w(Wd_re), 'dft_hid_im': _w(Wd_im)}
    _A_in = _A_setup()

    def _B_setup():
        B, S, D, F = (1, 2048, 512, 1792)
        return {'x': _w((lambda *s: torch.randn(*s, dtype=torch.bfloat16) * 0.05)(B, S, D)), 'w_gate': _w((lambda *s: torch.randn(*s, dtype=torch.bfloat16) * 0.4)(D, F)), 'w_up': _w((lambda *s: torch.randn(*s, dtype=torch.bfloat16) * 0.4)(D, F)), 'w_down': _w((lambda *s: torch.randn(*s, dtype=torch.bfloat16) * 0.4)(F, D))}
    _B_in = _B_setup()
    return {'A_x': _A_in['x'], 'A_dft_seq_re': _A_in['dft_seq_re'], 'A_dft_seq_im': _A_in['dft_seq_im'], 'A_dft_hid_re': _A_in['dft_hid_re'], 'A_dft_hid_im': _A_in['dft_hid_im'], 'B_x': _B_in['x'], 'B_w_gate': _B_in['w_gate'], 'B_w_up': _B_in['w_up'], 'B_w_down': _B_in['w_down'], 'c': _w((lambda *s: torch.randn(*s, dtype=torch.bfloat16) * 0.2)(1, 512) * 8.0), 'w_mod': _w((lambda *s: torch.randn(*s, dtype=torch.bfloat16) * 0.2)(512, 6 * 512) * 512 ** (-0.5) * 8.0)}

def reference(A_x, A_dft_seq_re, A_dft_seq_im, A_dft_hid_re, A_dft_hid_im, B_x, B_w_gate, B_w_up, B_w_down, c, w_mod):

    def _A_ref(x, dft_seq_re, dft_seq_im, dft_hid_re, dft_hid_im):
        a = torch.einsum('bsd,ed->bse', x, dft_hid_re)
        b = torch.einsum('bsd,ed->bse', x, dft_hid_im)
        y = torch.einsum('ts,bse->bte', dft_seq_re, a) - torch.einsum('ts,bse->bte', dft_seq_im, b)
        return y

    def _B_ref(x, w_gate, w_up, w_down):
        return _gelu(x @ w_gate) * (x @ w_up) @ w_down
    x = A_x
    mod = (_silu(c) @ w_mod).reshape(c.shape[0], 6, 1, -1)
    sa, ca, ga, sb, cb, gb = (mod[:, 0].clone(), mod[:, 1].clone(), mod[:, 2].clone(), mod[:, 3].clone(), mod[:, 4].clone(), mod[:, 5].clone())
    h = _layernorm(x, axis=-1) * (1 + ca) + sa
    x = x + ga * _A_ref(h, A_dft_seq_re, A_dft_seq_im, A_dft_hid_re, A_dft_hid_im)
    h = _layernorm(x, axis=-1) * (1 + cb) + sb
    x = x + gb * _B_ref(h, B_w_gate, B_w_up, B_w_down)
    return x
```

```asm
; @launch grid=(256,1,1) block=(768,1,1) lds=163840
.amdgcn_target "amdgcn-amd-amdhsa--gfx950"
.text
.p2align 8
.globl adaLN_cond__spectral_fnet__geglu_ffn__prompt_kernel
.type adaLN_cond__spectral_fnet__geglu_ffn__prompt_kernel,@function
adaLN_cond__spectral_fnet__geglu_ffn__prompt_kernel:
    s_cmp_ge_u32 s2, 256
    s_cbranch_scc1 adaLN_cond__spectral_fnet__geglu_ffn__prompt_kernel_exit
    s_load_dwordx2 s[6:7], s[0:1], 104
    s_load_dwordx2 s[4:5], s[0:1], 0
    s_load_dwordx4 s[8:11], s[0:1], 72
    s_load_dwordx2 s[44:45], s[0:1], 96
    v_and_b32 v1, 63, v0
    v_lshrrev_b32 v2, 6, v0
    s_nop 0
    v_readfirstlane_b32 s3, v2
    v_lshlrev_b32 v3, 4, v1
    v_lshrrev_b32 v4, 5, v1
    v_and_b32 v6, 31, v1
    s_and_b32 s20, s2, 7
    s_lshr_b32 s21, s2, 3
    s_and_b32 s26, s3, 3
    v_mov_b32 v8, 163328
    v_mov_b32 v12, 0
    v_mov_b32 v13, 0
    v_mov_b32 v14, 0
    v_mov_b32 v15, 0
    v_lshl_add_u32 v8, v6, 4, v8
    s_mov_b32 exec_lo, 0x3ff
    s_mov_b32 exec_hi, 0
    ds_write_b128 v8, v[12:15]
    s_mov_b64 exec, -1
    s_cmp_ge_u32 s3, 8
    s_cbranch_scc1 ka_gemv
    s_lshr_b32 s23, s21, 3
    s_lshl_b32 s22, s20, 2
    s_add_u32 s23, s23, s22
    s_and_b32 s24, s21, 7
    s_lshl_b32 s25, s3, 18
    s_lshl_b32 s27, s23, 10
    s_add_u32 s25, s25, s27
    s_mul_i32 s28, s3, 8320
    s_mov_b32 s27, s24
    v_and_b32 v12, 7, v1
    v_mul_u32_u24 v13, 1040, v12
    v_lshrrev_b32 v14, 3, v1
    v_lshl_add_u32 v13, v14, 7, v13
    v_add_u32 v13, s28, v13
    s_waitcnt lgkmcnt(0)
    s_mov_b32 s12, s4
    s_mov_b32 s13, s5
    s_mov_b32 s14, 0x200000
    s_mov_b32 s15, 0x20000
    s_mov_b32 s16, s6
    s_mov_b32 s17, s7
    s_mov_b32 s18, 0x1000000
    s_mov_b32 s19, 0x20000
    s_mov_b32 s46, 256
    s_mov_b32 s47, 0x20000
    s_mul_i32 s31, s27, 1040
    s_add_u32 m0, s31, s28
    s_lshl_b32 s32, s27, 15
    s_add_u32 s32, s32, s25
    buffer_load_dwordx4 v3, s[12:15], s32 offen lds
    s_add_u32 s27, s27, 1
    s_and_b32 s27, s27, 7
    s_mul_i32 s31, s27, 1040
    s_add_u32 m0, s31, s28
    s_lshl_b32 s32, s27, 15
    s_add_u32 s32, s32, s25
    buffer_load_dwordx4 v3, s[12:15], s32 offen lds
    s_add_u32 s27, s27, 1
    s_and_b32 s27, s27, 7
    s_mul_i32 s31, s27, 1040
    s_add_u32 m0, s31, s28
    s_lshl_b32 s32, s27, 15
    s_add_u32 s32, s32, s25
    buffer_load_dwordx4 v3, s[12:15], s32 offen lds
    s_add_u32 s27, s27, 1
    s_and_b32 s27, s27, 7
    s_mul_i32 s31, s27, 1040
    s_add_u32 m0, s31, s28
    s_lshl_b32 s32, s27, 15
    s_add_u32 s32, s32, s25
    buffer_load_dwordx4 v3, s[12:15], s32 offen lds
    s_add_u32 s27, s27, 1
    s_and_b32 s27, s27, 7
    s_mul_i32 s31, s27, 1040
    s_add_u32 m0, s31, s28
    s_lshl_b32 s32, s27, 15
    s_add_u32 s32, s32, s25
    buffer_load_dwordx4 v3, s[12:15], s32 offen lds
    s_add_u32 s27, s27, 1
    s_and_b32 s27, s27, 7
    s_mul_i32 s31, s27, 1040
    s_add_u32 m0, s31, s28
    s_lshl_b32 s32, s27, 15
    s_add_u32 s32, s32, s25
    buffer_load_dwordx4 v3, s[12:15], s32 offen lds
    s_add_u32 s27, s27, 1
    s_and_b32 s27, s27, 7
    s_mul_i32 s31, s27, 1040
    s_add_u32 m0, s31, s28
    s_lshl_b32 s32, s27, 15
    s_add_u32 s32, s32, s25
    buffer_load_dwordx4 v3, s[12:15], s32 offen lds
    s_add_u32 s27, s27, 1
    s_and_b32 s27, s27, 7
    s_mul_i32 s31, s27, 1040
    s_add_u32 m0, s31, s28
    s_lshl_b32 s32, s27, 15
    s_add_u32 s32, s32, s25
    buffer_load_dwordx4 v3, s[12:15], s32 offen lds
    s_barrier
    s_lshl_b32 s31, s3, 3
    v_add_u32 v17, s31, v12
    v_lshlrev_b32 v18, 1, v17
    v_lshlrev_b32 v17, 2, v17
    v_add_u32 v17, 66560, v17
    v_add_u32 v18, 66560, v18
    v_mov_b32 v24, 0
    v_mov_b32 v25, 0
    v_mov_b32 v26, 0
    v_mov_b32 v27, 0
    v_mov_b32 v28, 0
    v_mov_b32 v29, 0
    v_mov_b32 v30, 0
    v_mov_b32 v31, 0
    v_mov_b32 v21, 0
    v_mov_b32 v22, 0x3f803f80
    s_mov_b32 s36, 0xffff0000
    s_cmp_ge_u32 s3, 4
    s_cbranch_scc1 ka_nogen
    s_and_b32 s29, s3, 1
    s_lshr_b32 s30, s3, 1
    s_lshl_b32 s31, s29, 5
    v_add_u32 v7, s31, v6
    v_lshrrev_b32 v8, 1, v7
    v_cmp_eq_u32 vcc, 1, v7
    s_nop 1
    v_cndmask_b32 v8, v8, 32, vcc
    v_and_b32 v9, 1, v7
    v_cndmask_b32 v9, v9, 0, vcc
    v_cvt_f32_u32 v9, v9
    v_mul_f32 v9, 0xbe800000, v9
    v_cvt_f32_u32 v8, v8
    v_mul_f32 v8, 0x3c800000, v8
    v_lshlrev_b32 v10, 3, v4
    v_cvt_f32_u32 v10, v10
    v_fma_f32 v32, v8, v10, v9
    v_mul_f32 v11, 0x41800000, v8
    v_add_f32 v33, v32, v8
    v_add_f32 v34, v33, v8
    v_add_f32 v35, v34, v8
    v_add_f32 v36, v35, v8
    v_add_f32 v37, v36, v8
    v_add_f32 v38, v37, v8
    v_add_f32 v39, v38, v8
    v_add_f32 v40, v32, v11
    v_add_f32 v41, v33, v11
    v_add_f32 v42, v34, v11
    v_add_f32 v43, v35, v11
    v_add_f32 v44, v36, v11
    v_add_f32 v45, v37, v11
    v_add_f32 v46, v38, v11
    v_add_f32 v47, v39, v11
    v_add_f32 v48, v40, v11
    v_add_f32 v49, v41, v11
    v_add_f32 v50, v42, v11
    v_add_f32 v51, v43, v11
    v_add_f32 v52, v44, v11
    v_add_f32 v53, v45, v11
    v_add_f32 v54, v46, v11
    v_add_f32 v55, v47, v11
    v_add_f32 v56, v48, v11
    v_add_f32 v57, v49, v11
    v_add_f32 v58, v50, v11
    v_add_f32 v59, v51, v11
    v_add_f32 v60, v52, v11
    v_add_f32 v61, v53, v11
    v_add_f32 v62, v54, v11
    v_add_f32 v63, v55, v11
    v_cos_f32 v32, v32
    v_cos_f32 v33, v33
    v_cos_f32 v34, v34
    v_cos_f32 v35, v35
    v_cos_f32 v36, v36
    v_cos_f32 v37, v37
    v_cos_f32 v38, v38
    v_cos_f32 v39, v39
    v_cos_f32 v40, v40
    v_cos_f32 v41, v41
    v_cos_f32 v42, v42
    v_cos_f32 v43, v43
    v_cos_f32 v44, v44
    v_cos_f32 v45, v45
    v_cos_f32 v46, v46
    v_cos_f32 v47, v47
    v_cos_f32 v48, v48
    v_cos_f32 v49, v49
    v_cos_f32 v50, v50
    v_cos_f32 v51, v51
    v_cos_f32 v52, v52
    v_cos_f32 v53, v53
    v_cos_f32 v54, v54
    v_cos_f32 v55, v55
    v_cos_f32 v56, v56
    v_cos_f32 v57, v57
    v_cos_f32 v58, v58
    v_cos_f32 v59, v59
    v_cos_f32 v60, v60
    v_cos_f32 v61, v61
    v_cos_f32 v62, v62
    v_cos_f32 v63, v63
    v_bfe_u32 v15, v1, 2, 2
    v_lshl_add_u32 v15, v4, 3, v15
    v_mul_u32_u24 v15, 1040, v15
    v_and_b32 v16, 1, v1
    v_lshl_add_u32 v15, v16, 5, v15
    v_bfe_u32 v16, v1, 4, 1
    v_lshl_add_u32 v15, v16, 4, v15
    v_bfe_u32 v16, v1, 1, 1
    v_lshl_add_u32 v15, v16, 3, v15
    s_lshl_b32 s31, s24, 7
    s_lshl_b32 s32, s30, 6
    s_add_u32 s31, s31, s32
    v_add_u32 v15, s31, v15
    v_lshlrev_b32 v19, 5, v4
    v_add_u32 v19, 66560, v19
    v_lshlrev_b32 v20, 4, v4
    v_add_u32 v20, 66560, v20
    s_lshl_b32 s31, s3, 11
    s_add_u32 s31, s31, 74240
    v_lshlrev_b32 v21, 6, v6
    v_lshl_add_u32 v21, v4, 5, v21
    v_add_u32 v21, s31, v21
    v_add_u32 v23, s31, v3
    s_lshl_b32 s33, s24, 1
    s_add_u32 s33, s33, s30
    s_lshl_b32 s33, s33, 17
    s_lshl_b32 s34, s23, 12
    s_add_u32 s33, s33, s34
    s_add_u32 s33, s33, 0x100000
    s_lshl_b32 s34, s29, 11
    s_add_u32 s33, s33, s34
ka_nogen:
    s_waitcnt vmcnt(0)
ka_w1:
    ds_read_b128 v[64:67], v13 offset:0
    ds_read_b128 v[68:71], v13 offset:16
    ds_read_b128 v[72:75], v13 offset:32
    ds_read_b128 v[76:79], v13 offset:48
    ds_read_b128 v[80:83], v13 offset:64
    ds_read_b128 v[84:87], v13 offset:80
    ds_read_b128 v[88:91], v13 offset:96
    ds_read_b128 v[92:95], v13 offset:112
    s_waitcnt lgkmcnt(7)
    v_dot2c_f32_bf16 v24, v64, v22
    v_dot2c_f32_bf16 v28, v64, v64
    v_dot2c_f32_bf16 v25, v65, v22
    v_dot2c_f32_bf16 v29, v65, v65
    v_dot2c_f32_bf16 v26, v66, v22
    v_dot2c_f32_bf16 v30, v66, v66
    v_dot2c_f32_bf16 v27, v67, v22
    v_dot2c_f32_bf16 v31, v67, v67
    s_waitcnt lgkmcnt(6)
    v_dot2c_f32_bf16 v24, v68, v22
    v_dot2c_f32_bf16 v28, v68, v68
    v_dot2c_f32_bf16 v25, v69, v22
    v_dot2c_f32_bf16 v29, v69, v69
    v_dot2c_f32_bf16 v26, v70, v22
    v_dot2c_f32_bf16 v30, v70, v70
    v_dot2c_f32_bf16 v27, v71, v22
    v_dot2c_f32_bf16 v31, v71, v71
    s_waitcnt lgkmcnt(5)
    v_dot2c_f32_bf16 v24, v72, v22
    v_dot2c_f32_bf16 v28, v72, v72
    v_dot2c_f32_bf16 v25, v73, v22
    v_dot2c_f32_bf16 v29, v73, v73
    v_dot2c_f32_bf16 v26, v74, v22
    v_dot2c_f32_bf16 v30, v74, v74
    v_dot2c_f32_bf16 v27, v75, v22
    v_dot2c_f32_bf16 v31, v75, v75
    s_waitcnt lgkmcnt(4)
    v_dot2c_f32_bf16 v24, v76, v22
    v_dot2c_f32_bf16 v28, v76, v76
    v_dot2c_f32_bf16 v25, v77, v22
    v_dot2c_f32_bf16 v29, v77, v77
    v_dot2c_f32_bf16 v26, v78, v22
    v_dot2c_f32_bf16 v30, v78, v78
    v_dot2c_f32_bf16 v27, v79, v22
    v_dot2c_f32_bf16 v31, v79, v79
    s_waitcnt lgkmcnt(3)
    v_dot2c_f32_bf16 v24, v80, v22
    v_dot2c_f32_bf16 v28, v80, v80
    v_dot2c_f32_bf16 v25, v81, v22
    v_dot2c_f32_bf16 v29, v81, v81
    v_dot2c_f32_bf16 v26, v82, v22
    v_dot2c_f32_bf16 v30, v82, v82
    v_dot2c_f32_bf16 v27, v83, v22
    v_dot2c_f32_bf16 v31, v83, v83
    s_waitcnt lgkmcnt(2)
    v_dot2c_f32_bf16 v24, v84, v22
    v_dot2c_f32_bf16 v28, v84, v84
    v_dot2c_f32_bf16 v25, v85, v22
    v_dot2c_f32_bf16 v29, v85, v85
    v_dot2c_f32_bf16 v26, v86, v22
    v_dot2c_f32_bf16 v30, v86, v86
    v_dot2c_f32_bf16 v27, v87, v22
    v_dot2c_f32_bf16 v31, v87, v87
    s_waitcnt lgkmcnt(1)
    v_dot2c_f32_bf16 v24, v88, v22
    v_dot2c_f32_bf16 v28, v88, v88
    v_dot2c_f32_bf16 v25, v89, v22
    v_dot2c_f32_bf16 v29, v89, v89
    v_dot2c_f32_bf16 v26, v90, v22
    v_dot2c_f32_bf16 v30, v90, v90
    v_dot2c_f32_bf16 v27, v91, v22
    v_dot2c_f32_bf16 v31, v91, v91
    s_waitcnt lgkmcnt(0)
    v_dot2c_f32_bf16 v24, v92, v22
    v_dot2c_f32_bf16 v28, v92, v92
    v_dot2c_f32_bf16 v25, v93, v22
    v_dot2c_f32_bf16 v29, v93, v93
    v_dot2c_f32_bf16 v26, v94, v22
    v_dot2c_f32_bf16 v30, v94, v94
    v_dot2c_f32_bf16 v27, v95, v22
    v_dot2c_f32_bf16 v31, v95, v95
    s_nop 2
    v_add_f32 v24, v24, v25
    v_add_f32 v26, v26, v27
    v_add_f32 v28, v28, v29
    v_add_f32 v30, v30, v31
    v_add_f32 v24, v24, v26
    v_add_f32 v25, v28, v30
    s_nop 0
    v_add_f32_dpp v24, v24, v24 row_ror:8
    v_add_f32_dpp v25, v25, v25 row_ror:8
    v_mov_b32 v26, v24
    v_mov_b32 v27, v25
    s_nop 0
    v_permlane16_swap_b32 v26, v24
    v_permlane16_swap_b32 v27, v25
    v_add_f32 v24, v24, v26
    v_add_f32 v25, v25, v27
    v_mov_b32 v26, v24
    v_mov_b32 v27, v25
    s_nop 0
    v_permlane32_swap_b32 v26, v24
    v_permlane32_swap_b32 v27, v25
    v_add_f32 v24, v24, v26
    v_add_f32 v25, v25, v27
    v_mul_f32 v24, 0xbb000000, v24
    v_mul_f32 v25, 0x3b000000, v25
    v_fma_f32 v25, -v24, v24, v25
    v_max_f32 v25, 0, v25
    v_add_f32 v25, 0x3727c5ac, v25
    v_rsq_f32 v25, v25
    v_cvt_pk_bf16_f32 v26, v24, v24
    v_and_b32 v27, s36, v26
    v_sub_f32 v27, v24, v27
    v_cvt_pk_bf16_f32 v27, v27, v27
    ds_write_b32 v17, v25
    ds_write_b16 v18, v26 offset:256
    ds_write_b16 v18, v27 offset:384
    s_waitcnt lgkmcnt(0)
    v_mov_b32 v8, 163456
    v_mov_b32 v9, 1
    s_mov_b64 exec, 1
    ds_add_u32 v8, v9
    s_mov_b64 exec, -1
    s_cmp_ge_u32 s3, 4
    s_cbranch_scc1 ka_pf
    v_mov_b32 v8, 163456
    s_mov_b32 s57, 0
ka_spin:
    ds_read_b32 v9, v8
    s_waitcnt lgkmcnt(0)
    v_readfirstlane_b32 s56, v9
    s_nop 0
    s_cmp_ge_u32 s56, 8
    s_cbranch_scc1 ka_spin_ok
    s_sleep 1
    s_add_u32 s57, s57, 1
    s_cmp_lt_u32 s57, 2097152
    s_cbranch_scc1 ka_spin
ka_spin_ok:
    ds_read_b128 v[64:67], v19 offset:0
    ds_read_b128 v[68:71], v19 offset:16
    ds_read_b128 v[72:75], v19 offset:64
    ds_read_b128 v[76:79], v19 offset:80
    ds_read_b128 v[80:83], v19 offset:128
    ds_read_b128 v[84:87], v19 offset:144
    ds_read_b128 v[88:91], v19 offset:192
    ds_read_b128 v[92:95], v19 offset:208
    ds_read_b64_tr_b16 v[96:97], v15 offset:0
    ds_read_b64_tr_b16 v[98:99], v15 offset:4160
    ds_read_b64_tr_b16 v[100:101], v15 offset:16640
    ds_read_b64_tr_b16 v[102:103], v15 offset:20800
    ds_read_b64_tr_b16 v[104:105], v15 offset:33280
    ds_read_b64_tr_b16 v[106:107], v15 offset:37440
    ds_read_b64_tr_b16 v[108:109], v15 offset:49920
    ds_read_b64_tr_b16 v[110:111], v15 offset:54080
    s_waitcnt lgkmcnt(14)
    v_pk_mul_f32 v[32:33], v[32:33], v[64:65]
    v_pk_mul_f32 v[34:35], v[34:35], v[66:67]
    v_pk_mul_f32 v[36:37], v[36:37], v[68:69]
    v_pk_mul_f32 v[38:39], v[38:39], v[70:71]
    v_cvt_pk_bf16_f32 v32, v32, v33
    v_cvt_pk_bf16_f32 v33, v34, v35
    v_cvt_pk_bf16_f32 v34, v36, v37
    v_cvt_pk_bf16_f32 v35, v38, v39
    ds_read_b128 v[112:115], v20 offset:256
    ds_read_b128 v[116:119], v20 offset:384
    s_waitcnt lgkmcnt(14)
    v_pk_mul_f32 v[40:41], v[40:41], v[72:73]
    v_pk_mul_f32 v[42:43], v[42:43], v[74:75]
    v_pk_mul_f32 v[44:45], v[44:45], v[76:77]
    v_pk_mul_f32 v[46:47], v[46:47], v[78:79]
    v_cvt_pk_bf16_f32 v40, v40, v41
    v_cvt_pk_bf16_f32 v41, v42, v43
    v_cvt_pk_bf16_f32 v42, v44, v45
    v_cvt_pk_bf16_f32 v43, v46, v47
    ds_read_b128 v[120:123], v20 offset:288
    ds_read_b128 v[124:127], v20 offset:416
    s_waitcnt lgkmcnt(14)
    v_pk_mul_f32 v[48:49], v[48:49], v[80:81]
    v_pk_mul_f32 v[50:51], v[50:51], v[82:83]
    v_pk_mul_f32 v[52:53], v[52:53], v[84:85]
    v_pk_mul_f32 v[54:55], v[54:55], v[86:87]
    v_cvt_pk_bf16_f32 v48, v48, v49
    v_cvt_pk_bf16_f32 v49, v50, v51
    v_cvt_pk_bf16_f32 v50, v52, v53
    v_cvt_pk_bf16_f32 v51, v54, v55
    ds_read_b128 v[128:131], v20 offset:320
    ds_read_b128 v[132:135], v20 offset:448
    s_waitcnt lgkmcnt(14)
    v_pk_mul_f32 v[56:57], v[56:57], v[88:89]
    v_pk_mul_f32 v[58:59], v[58:59], v[90:91]
    v_pk_mul_f32 v[60:61], v[60:61], v[92:93]
    v_pk_mul_f32 v[62:63], v[62:63], v[94:95]
    v_cvt_pk_bf16_f32 v56, v56, v57
    v_cvt_pk_bf16_f32 v57, v58, v59
    v_cvt_pk_bf16_f32 v58, v60, v61
    v_cvt_pk_bf16_f32 v59, v62, v63
    ds_read_b128 v[136:139], v20 offset:352
    ds_read_b128 v[140:143], v20 offset:480
    s_waitcnt lgkmcnt(14)
    v_mfma_f32_32x32x16_bf16 v[64:79], v[96:99], v[32:35], 0
    s_waitcnt lgkmcnt(12)
    v_mfma_f32_32x32x16_bf16 v[64:79], v[100:103], v[40:43], v[64:79]
    s_waitcnt lgkmcnt(10)
    v_mfma_f32_32x32x16_bf16 v[64:79], v[104:107], v[48:51], v[64:79]
    s_waitcnt lgkmcnt(8)
    v_mfma_f32_32x32x16_bf16 v[64:79], v[108:111], v[56:59], v[64:79]
    s_waitcnt lgkmcnt(6)
    v_mfma_f32_32x32x16_bf16 v[64:79], v[112:115], v[32:35], v[64:79]
    v_mfma_f32_32x32x16_bf16 v[64:79], v[116:119], v[32:35], v[64:79]
    s_waitcnt lgkmcnt(4)
    v_mfma_f32_32x32x16_bf16 v[64:79], v[120:123], v[40:43], v[64:79]
    v_mfma_f32_32x32x16_bf16 v[64:79], v[124:127], v[40:43], v[64:79]
    s_waitcnt lgkmcnt(2)
    v_mfma_f32_32x32x16_bf16 v[64:79], v[128:131], v[48:51], v[64:79]
    v_mfma_f32_32x32x16_bf16 v[64:79], v[132:135], v[48:51], v[64:79]
    s_waitcnt lgkmcnt(0)
    v_mfma_f32_32x32x16_bf16 v[64:79], v[136:139], v[56:59], v[64:79]
    v_mfma_f32_32x32x16_bf16 v[64:79], v[140:143], v[56:59], v[64:79]
    s_nop 7
    s_nop 3
    v_cvt_pk_bf16_f32 v80, v64, v65
    v_cvt_pk_bf16_f32 v81, v66, v67
    v_cvt_pk_bf16_f32 v82, v68, v69
    v_cvt_pk_bf16_f32 v83, v70, v71
    v_cvt_pk_bf16_f32 v84, v72, v73
    v_cvt_pk_bf16_f32 v85, v74, v75
    v_cvt_pk_bf16_f32 v86, v76, v77
    v_cvt_pk_bf16_f32 v87, v78, v79
    ds_write_b128 v21, v[80:83]
    ds_write_b128 v21, v[84:87] offset:16
    s_waitcnt lgkmcnt(0)
    ds_read_b128 v[88:91], v23
    ds_read_b128 v[92:95], v23 offset:1024
    s_waitcnt lgkmcnt(1)
    buffer_store_dwordx4 v[88:91], v3, s[16:19], s33 offen sc1
    s_waitcnt lgkmcnt(0)
    buffer_store_dwordx4 v[92:95], v3, s[16:19], s33 offen offset:1024 sc1
    s_waitcnt vmcnt(0)
    v_mov_b32 v8, 163464
    v_mov_b32 v9, 1
    s_mov_b64 exec, 1
    ds_add_rtn_u32 v10, v8, v9
    ds_read_b32 v11, v8 offset:4
    s_waitcnt lgkmcnt(0)
    v_readfirstlane_b32 s56, v10
    v_readfirstlane_b32 s57, v11
    s_mov_b64 exec, -1
    s_cmp_lg_u32 s56, 4
    s_cbranch_scc1 km_start
    s_branch ka_signal
ka_signal:
    s_cmp_lg_u32 s57, 0
    s_cbranch_scc1 ka_inited
    v_mov_b32 v8, 163468
    s_mov_b32 s57, 0
ka_iw:
    ds_read_b32 v9, v8
    s_waitcnt lgkmcnt(0)
    v_readfirstlane_b32 s56, v9
    s_nop 0
    s_cmp_ge_u32 s56, 1
    s_cbranch_scc1 ka_iw_ok
    s_sleep 1
    s_add_u32 s57, s57, 1
    s_cmp_lt_u32 s57, 2097152
    s_cbranch_scc1 ka_iw
ka_iw_ok:
ka_inited:
    s_and_b32 s57, s2, 15
    s_lshl_b32 s57, s57, 7
    s_add_u32 s57, s57, 0x13000
    s_mov_b32 s56, 1
    s_atomic_add s56, s[6:7], s57 glc
    s_waitcnt lgkmcnt(0)
    s_cmp_lg_u32 s56, 15
    s_cbranch_scc1 km_start
    s_mov_b64 exec, 1
    v_mov_b32 v8, 0
    v_mov_b32 v9, 1
    buffer_store_dword v9, v8, s[16:19], s57 offen offset:2048 sc1
    s_mov_b64 exec, -1
    s_branch km_start
ka_pf:
    s_cmp_lg_u32 s3, 4
    s_cbranch_scc1 km_start
    v_mov_b32 v8, 0
    s_mov_b32 s57, 0
ka_gi_lp:
    buffer_load_dword v9, v8, s[44:47], 0 offen sc1
    s_waitcnt vmcnt(0)
    v_readfirstlane_b32 s56, v9
    s_nop 0
    s_cmp_lg_u32 s56, 0
    s_cbranch_scc1 ka_gi_ok
    s_sleep 2
    s_add_u32 s57, s57, 1
    s_cmp_lt_u32 s57, 131072
    s_cbranch_scc1 ka_gi_lp
ka_gi_ok:
    v_mov_b32 v8, 163468
    v_mov_b32 v9, 1
    s_mov_b64 exec, 1
    ds_add_u32 v8, v9
    s_mov_b64 exec, -1
    s_branch km_start
ka_gemv:
    v_and_b32 v5, 255, v0
    v_lshrrev_b32 v7, 3, v5
    v_and_b32 v8, 7, v5
    s_lshr_b32 s22, s2, 2
    s_sub_u32 s22, s22, 16
    s_and_b32 s23, s2, 3
    v_lshlrev_b32 v9, 3, v7
    s_lshl_b32 s24, s23, 8
    v_mul_u32_u24 v10, 24576, v7
    v_lshl_add_u32 v10, v8, 4, v10
    s_mul_i32 s25, s23, 786432
    s_lshl_b32 s27, s22, 7
    s_add_u32 s25, s25, s27
    v_lshrrev_b32 v30, 4, v5
    v_lshlrev_b32 v30, 8, v30
    v_lshl_add_u32 v30, v8, 5, v30
    v_add_u32 v30, 67072, v30
    s_waitcnt lgkmcnt(0)
    s_mov_b32 s12, s8
    s_mov_b32 s13, s9
    s_mov_b32 s14, 0x400
    s_mov_b32 s15, 0x20000
    s_mov_b32 s28, s10
    s_mov_b32 s29, s11
    s_mov_b32 s30, 0x300000
    s_mov_b32 s31, 0x20000
    s_mov_b32 s16, s6
    s_mov_b32 s17, s7
    s_mov_b32 s18, 0x1000000
    s_mov_b32 s19, 0x20000
    s_mov_b32 s46, 256
    s_mov_b32 s47, 0x20000
    s_cmp_ge_u32 s2, 64
    s_cbranch_scc1 ka_job
    s_lshl_b32 s25, s2, 4
    s_add_u32 s25, s25, s3
    s_cmp_lg_u32 s25, 24
    s_cbranch_scc1 ka_nj
    s_mov_b32 s24, 0x13000
    buffer_store_dwordx4 v[12:15], v3, s[16:19], s24 offen offset:0 sc1
    buffer_store_dwordx4 v[12:15], v3, s[16:19], s24 offen offset:1024 sc1
    buffer_store_dwordx4 v[12:15], v3, s[16:19], s24 offen offset:2048 sc1
    buffer_store_dwordx4 v[12:15], v3, s[16:19], s24 offen offset:3072 sc1
ka_nj:
    s_barrier
    s_cmp_lg_u32 s25, 24
    s_cbranch_scc1 ka_nj2
    s_waitcnt vmcnt(0)
    s_mov_b64 exec, 1
    v_mov_b32 v8, 0
    v_mov_b32 v9, 1
    buffer_store_dword v9, v8, s[44:47], 0 offen sc1
    s_mov_b64 exec, -1
    s_mov_b32 s24, 0x10000
    buffer_store_dwordx4 v[12:15], v3, s[16:19], s24 offen sc1
    s_add_u32 s24, s24, 1024
    buffer_store_dwordx4 v[12:15], v3, s[16:19], s24 offen sc1
    s_add_u32 s24, s24, 1024
    buffer_store_dwordx4 v[12:15], v3, s[16:19], s24 offen sc1
    s_add_u32 s24, s24, 1024
    buffer_store_dwordx4 v[12:15], v3, s[16:19], s24 offen sc1
    s_add_u32 s24, s24, 1024
    buffer_store_dwordx4 v[12:15], v3, s[16:19], s24 offen sc1
    s_add_u32 s24, s24, 1024
    buffer_store_dwordx4 v[12:15], v3, s[16:19], s24 offen sc1
    s_add_u32 s24, s24, 1024
    buffer_store_dwordx4 v[12:15], v3, s[16:19], s24 offen sc1
    s_add_u32 s24, s24, 1024
    buffer_store_dwordx4 v[12:15], v3, s[16:19], s24 offen sc1
    s_add_u32 s24, s24, 1024
    buffer_store_dwordx4 v[12:15], v3, s[16:19], s24 offen sc1
    s_add_u32 s24, s24, 1024
    buffer_store_dwordx4 v[12:15], v3, s[16:19], s24 offen sc1
    s_add_u32 s24, s24, 1024
ka_nj2:
    s_cmp_ge_u32 s21, 2
    s_cbranch_scc1 ka_npf
    s_cmp_lt_u32 s26, 2
    s_cbranch_scc1 ka_npf
    s_getpc_b64 s[40:41]
ka_pc:
    s_add_u32 s40, s40, km_start-ka_pc
    s_addc_u32 s41, s41, 0
    s_mov_b32 s42, adaLN_cond__spectral_fnet__geglu_ffn__prompt_kernel_exit-km_start
    s_mov_b32 s43, 0x20000
    s_and_b32 s24, s21, 1
    s_lshl_b32 s24, s24, 1
    s_add_u32 s24, s24, s26
    s_sub_u32 s24, s24, 2
    s_lshl_b32 s24, s24, 13
    v_lshlrev_b32 v8, 7, v1
    buffer_load_dword v139, v8, s[40:43], s24 offen
ka_npf:
    s_cmp_lg_u32 s3, 8
    s_cbranch_scc1 km_start
    s_waitcnt vmcnt(0)
    v_mov_b32 v8, 163464
    v_mov_b32 v9, 1
    s_mov_b64 exec, 1
    ds_add_rtn_u32 v10, v8, v9
    ds_read_b32 v11, v8 offset:4
    s_waitcnt lgkmcnt(0)
    v_readfirstlane_b32 s56, v10
    v_readfirstlane_b32 s57, v11
    s_mov_b64 exec, -1
    s_cmp_lg_u32 s56, 4
    s_cbranch_scc1 km_start
    s_branch ka_signal
ka_job:
    buffer_load_dwordx2 v[12:13], v9, s[12:15], s24 offen
    s_barrier
    buffer_load_dwordx4 v[32:35], v10, s[28:31], s25 offen
    s_add_u32 s25, s25, 6144
    buffer_load_dwordx4 v[36:39], v10, s[28:31], s25 offen
    s_add_u32 s25, s25, 6144
    buffer_load_dwordx4 v[40:43], v10, s[28:31], s25 offen
    s_add_u32 s25, s25, 6144
    buffer_load_dwordx4 v[44:47], v10, s[28:31], s25 offen
    s_mov_b32 s36, 0xffff0000
    s_mov_b32 s40, 0x05040100
    s_mov_b32 s41, 0x07060302
    v_mov_b32 v64, 0
    v_mov_b32 v65, 0
    v_mov_b32 v66, 0
    v_mov_b32 v67, 0
    v_mov_b32 v68, 0
    v_mov_b32 v69, 0
    v_mov_b32 v70, 0
    v_mov_b32 v71, 0
    s_waitcnt vmcnt(4)
    v_lshlrev_b32 v16, 16, v12
    v_and_b32 v17, s36, v12
    v_lshlrev_b32 v18, 16, v13
    v_and_b32 v19, s36, v13
    v_mul_f32 v20, 0xbfb8aa3b, v16
    v_mul_f32 v21, 0xbfb8aa3b, v17
    v_mul_f32 v22, 0xbfb8aa3b, v18
    v_mul_f32 v23, 0xbfb8aa3b, v19
    v_exp_f32 v20, v20
    v_exp_f32 v21, v21
    v_exp_f32 v22, v22
    v_exp_f32 v23, v23
    v_add_f32 v20, 1.0, v20
    v_add_f32 v21, 1.0, v21
    v_add_f32 v22, 1.0, v22
    v_add_f32 v23, 1.0, v23
    v_rcp_f32 v20, v20
    v_rcp_f32 v21, v21
    v_rcp_f32 v22, v22
    v_rcp_f32 v23, v23
    v_mul_f32 v20, v20, v16
    v_mul_f32 v21, v21, v17
    v_mul_f32 v22, v22, v18
    v_mul_f32 v23, v23, v19
    v_cvt_pk_bf16_f32 v12, v20, v21
    v_cvt_pk_bf16_f32 v13, v22, v23
    s_waitcnt vmcnt(2)
    v_perm_b32 v48, v36, v32, s40
    v_perm_b32 v49, v36, v32, s41
    v_perm_b32 v50, v37, v33, s40
    v_perm_b32 v51, v37, v33, s41
    v_perm_b32 v52, v38, v34, s40
    v_perm_b32 v53, v38, v34, s41
    v_perm_b32 v54, v39, v35, s40
    v_perm_b32 v55, v39, v35, s41
    v_dot2c_f32_bf16 v64, v48, v12
    v_dot2c_f32_bf16 v65, v49, v12
    v_dot2c_f32_bf16 v66, v50, v12
    v_dot2c_f32_bf16 v67, v51, v12
    v_dot2c_f32_bf16 v68, v52, v12
    v_dot2c_f32_bf16 v69, v53, v12
    v_dot2c_f32_bf16 v70, v54, v12
    v_dot2c_f32_bf16 v71, v55, v12
    s_nop 2
    s_waitcnt vmcnt(0)
    v_perm_b32 v48, v44, v40, s40
    v_perm_b32 v49, v44, v40, s41
    v_perm_b32 v50, v45, v41, s40
    v_perm_b32 v51, v45, v41, s41
    v_perm_b32 v52, v46, v42, s40
    v_perm_b32 v53, v46, v42, s41
    v_perm_b32 v54, v47, v43, s40
    v_perm_b32 v55, v47, v43, s41
    v_dot2c_f32_bf16 v64, v48, v13
    v_dot2c_f32_bf16 v65, v49, v13
    v_dot2c_f32_bf16 v66, v50, v13
    v_dot2c_f32_bf16 v67, v51, v13
    v_dot2c_f32_bf16 v68, v52, v13
    v_dot2c_f32_bf16 v69, v53, v13
    v_dot2c_f32_bf16 v70, v54, v13
    v_dot2c_f32_bf16 v71, v55, v13
    s_nop 2
    v_add_f32_dpp v64, v64, v64 row_ror:8
    v_add_f32_dpp v65, v65, v65 row_ror:8
    v_add_f32_dpp v66, v66, v66 row_ror:8
    v_add_f32_dpp v67, v67, v67 row_ror:8
    v_add_f32_dpp v68, v68, v68 row_ror:8
    v_add_f32_dpp v69, v69, v69 row_ror:8
    v_add_f32_dpp v70, v70, v70 row_ror:8
    v_add_f32_dpp v71, v71, v71 row_ror:8
    ds_write_b128 v30, v[64:67]
    ds_write_b128 v30, v[68:71] offset:16
    s_waitcnt lgkmcnt(0)
    v_mov_b32 v8, 163460
    v_mov_b32 v9, 1
    s_mov_b64 exec, 1
    ds_add_rtn_u32 v10, v8, v9
    s_waitcnt lgkmcnt(0)
    v_readfirstlane_b32 s56, v10
    s_mov_b64 exec, -1
    s_cmp_lg_u32 s56, 3
    s_cbranch_scc1 km_start
    v_lshlrev_b32 v10, 2, v1
    v_add_u32 v10, 67072, v10
    ds_read2st64_b32 v[32:33], v10 offset0:0 offset1:1
    ds_read2st64_b32 v[34:35], v10 offset0:2 offset1:3
    ds_read2st64_b32 v[36:37], v10 offset0:4 offset1:5
    ds_read2st64_b32 v[38:39], v10 offset0:6 offset1:7
    ds_read2st64_b32 v[40:41], v10 offset0:8 offset1:9
    ds_read2st64_b32 v[42:43], v10 offset0:10 offset1:11
    ds_read2st64_b32 v[44:45], v10 offset0:12 offset1:13
    ds_read2st64_b32 v[46:47], v10 offset0:14 offset1:15
    s_lshr_b32 s24, s22, 3
    s_lshl_b32 s25, s22, 6
    v_add_u32 v23, s25, v1
    v_and_b32 v26, 511, v23
    v_sub_u32 v27, 512, v26
    v_and_b32 v27, 255, v27
    v_or_b32 v27, 256, v27
    v_cmp_lt_u32 vcc, 255, v26
    s_sub_u32 s25, s24, 2
    s_cmp_lt_u32 s25, 3
    s_cselect_b64 vcc, vcc, 0
    v_cndmask_b32 v27, v26, v27, vcc
    v_lshlrev_b32 v27, 2, v27
    s_lshl_b32 s24, s24, 11
    s_mul_i32 s25, s23, 12288
    s_add_u32 s24, s24, s25
    s_waitcnt lgkmcnt(0)
    v_add_f32 v32, v32, v40
    v_add_f32 v33, v33, v41
    v_add_f32 v34, v34, v42
    v_add_f32 v35, v35, v43
    v_add_f32 v36, v36, v44
    v_add_f32 v37, v37, v45
    v_add_f32 v38, v38, v46
    v_add_f32 v39, v39, v47
    v_add_f32 v32, v32, v36
    v_add_f32 v33, v33, v37
    v_add_f32 v34, v34, v38
    v_add_f32 v35, v35, v39
    v_add_f32 v32, v32, v34
    v_add_f32 v33, v33, v35
    v_add_f32 v32, v32, v33
    buffer_store_dword v32, v27, s[16:19], s24 offen sc1
    s_waitcnt vmcnt(0)
    v_mov_b32 v8, 163464
    v_mov_b32 v9, 1
    s_mov_b64 exec, 1
    ds_add_rtn_u32 v10, v8, v9
    ds_read_b32 v11, v8 offset:4
    s_waitcnt lgkmcnt(0)
    v_readfirstlane_b32 s56, v10
    v_readfirstlane_b32 s57, v11
    s_mov_b64 exec, -1
    s_cmp_lg_u32 s56, 4
    s_cbranch_scc1 km_start
    s_branch ka_signal
km_start:
    s_and_b32 s22, s21, 7
    s_lshr_b32 s23, s21, 3
    s_lshl_b32 s24, s20, 2
    s_add_u32 s23, s23, s24
    s_lshl_b32 s25, s26, 2
    s_lshl_b32 s24, s22, 1
    s_add_u32 s25, s25, s24
    s_cmp_lt_u32 s3, 8
    s_cbranch_scc1 km_compute
    s_load_dwordx4 s[8:11], s[0:1], 48
    s_setprio 3
    v_lshrrev_b32 v5, 3, v1
    v_lshlrev_b32 v5, 12, v5
    v_and_b32 v7, 7, v1
    v_lshrrev_b32 v8, 2, v1
    v_and_b32 v8, 4, v8
    v_xor_b32 v7, v7, v8
    v_lshl_add_u32 v5, v7, 4, v5
    s_lshl_b32 s27, s23, 7
    s_add_u32 s27, s27, 0x100000
    s_lshl_b32 s28, s26, 12
    s_add_u32 s28, s28, 74240
    s_lshl_b32 s33, s26, 9
    v_lshlrev_b32 v16, 4, v6
    v_add_u32 v16, s33, v16
    v_lshlrev_b32 v17, 11, v4
    v_sub_u32 v17, 2048, v17
    v_add_u32 v17, v17, v16
    v_add_u32 v18, 147968, v16
    v_lshrrev_b32 v20, 1, v16
    v_add_u32 v20, 159744, v20
    v_cvt_f32_u32 v19, v4
    v_mul_f32 v21, 0x44ffe000, v19
    v_add_f32 v21, 1.0, v21
    v_sub_f32 v19, 1.0, v19
    s_and_b32 s37, s26, 1
    s_lshr_b32 s38, s26, 1
    s_and_b32 s49, s21, 3
    s_lshr_b32 s48, s21, 2
    s_lshl_b32 s50, s49, 1
    s_add_u32 s50, s50, s48
    s_lshl_b32 s50, s50, 1
    s_and_b32 s50, s50, 15
    s_and_b32 s51, s20, 4
    s_add_u32 s49, s49, s51
    s_min_u32 s51, s49, 6
    s_cmp_ge_u32 s21, 28
    s_cselect_b32 s48, s51, s48
    s_and_b32 s51, s20, 3
    s_mul_i32 s51, s51, 7
    s_add_u32 s48, s48, s51
    s_waitcnt lgkmcnt(0)
    s_cmp_eq_u32 s37, 1
    s_cselect_b32 s40, s10, s8
    s_cselect_b32 s41, s11, s9
    s_mov_b32 s42, 1835008
    s_mov_b32 s43, 0x20000
    v_lshrrev_b32 v140, 3, v1
    v_bfe_u32 v141, v1, 1, 2
    v_and_b32 v142, 2, v140
    v_or_b32 v142, s37, v142
    v_xor_b32 v141, v141, v142
    v_lshlrev_b32 v141, 5, v141
    v_and_b32 v142, 1, v1
    v_lshl_add_u32 v141, v142, 4, v141
    v_mul_u32_u24 v142, 3584, v140
    v_add_u32 v144, v142, v141
    v_sub_u32 v142, 942592, v142
    v_add_u32 v145, v142, v141
    v_subrev_u32 v146, 917504, v145
    v_cmp_eq_u32 vcc, 0, v140
    s_nop 1
    v_cndmask_b32 v146, v145, v146, vcc
    s_lshl_b32 s30, s48, 7
    s_cmp_eq_u32 s26, 3
    s_cbranch_scc1 km_ga_poll
km_ga_wait:
    v_mov_b32 v8, 163472
    s_mov_b32 s57, 0
km_spinGA:
    ds_read_b32 v9, v8
    s_waitcnt lgkmcnt(0)
    v_readfirstlane_b32 s56, v9
    s_nop 0
    s_cmp_ge_u32 s56, 1
    s_cbranch_scc1 km_spinGA_ok
    s_sleep 1
    s_add_u32 s57, s57, 1
    s_cmp_lt_u32 s57, 2097152
    s_cbranch_scc1 km_spinGA
km_spinGA_ok:
    s_branch km_ga_go
km_ga_poll:
    v_mov_b32 v8, 163468
    s_mov_b32 s57, 0
km_gi:
    ds_read_b32 v9, v8
    s_waitcnt lgkmcnt(0)
    v_readfirstlane_b32 s56, v9
    s_nop 0
    s_cmp_ge_u32 s56, 1
    s_cbranch_scc1 km_gi_ok
    s_sleep 1
    s_add_u32 s57, s57, 1
    s_cmp_lt_u32 s57, 2097152
    s_cbranch_scc1 km_gi
km_gi_ok:
    v_mov_b32 v8, 163464
    s_mov_b32 s57, 0
km_spinA2:
    ds_read_b32 v9, v8
    s_waitcnt lgkmcnt(0)
    v_readfirstlane_b32 s56, v9
    s_nop 0
    s_cmp_ge_u32 s56, 5
    s_cbranch_scc1 km_spinA2_ok
    s_sleep 1
    s_add_u32 s57, s57, 1
    s_cmp_lt_u32 s57, 2097152
    s_cbranch_scc1 km_spinA2
km_spinA2_ok:
    v_and_b32 v8, 15, v1
    v_lshlrev_b32 v8, 7, v8
    s_mov_b32 s57, 0
    s_mov_b32 s32, 0x13800
    s_mov_b32 exec_lo, 0xffff
    s_mov_b32 exec_hi, 0
km_ga_lp:
    buffer_load_dword v9, v8, s[16:19], s32 offen sc1
    s_waitcnt vmcnt(0)
    v_cmp_ne_u32 vcc, 0, v9
    s_nop 0
    s_cmp_eq_u32 vcc_lo, 0xffff
    s_cbranch_scc1 km_ga_ok
    s_sleep 2
    s_add_u32 s57, s57, 1
    s_cmp_lt_u32 s57, 131072
    s_cbranch_scc1 km_ga_lp
km_ga_ok:
    s_mov_b64 exec, -1
    v_mov_b32 v8, 163472
    v_mov_b32 v9, 1
    s_mov_b64 exec, 1
    ds_add_u32 v8, v9
    s_mov_b64 exec, -1
km_ga_go:
    s_mov_b32 s46, 0xffff0000
    s_mov_b32 s34, 12288
    s_mov_b32 s35, 24576
    s_mov_b32 s36, 36864
    buffer_load_dwordx4 v[32:35], v17, s[16:19], 0 offen sc1
    buffer_load_dwordx4 v[36:39], v17, s[16:19], s34 offen sc1
    buffer_load_dwordx4 v[40:43], v17, s[16:19], s35 offen sc1
    buffer_load_dwordx4 v[44:47], v17, s[16:19], s36 offen sc1
    s_add_u32 s32, s25, 0
    s_and_b32 s32, s32, 15
    s_lshl_b32 s32, s32, 17
    s_add_u32 s32, s32, s27
    s_add_u32 m0, s28, 0
    s_nop 0
    buffer_load_dwordx4 v5, s[16:19], s32 offen sc1 lds
    s_add_u32 m0, m0, 1024
    s_add_u32 s32, s32, 32768
    buffer_load_dwordx4 v5, s[16:19], s32 offen sc1 lds
    s_add_u32 m0, m0, 1024
    s_add_u32 s32, s32, 32768
    buffer_load_dwordx4 v5, s[16:19], s32 offen sc1 lds
    s_add_u32 m0, m0, 1024
    s_add_u32 s32, s32, 32768
    buffer_load_dwordx4 v5, s[16:19], s32 offen sc1 lds
    s_add_u32 s32, s25, 1
    s_and_b32 s32, s32, 15
    s_lshl_b32 s32, s32, 17
    s_add_u32 s32, s32, s27
    s_add_u32 m0, s28, 16384
    s_nop 0
    buffer_load_dwordx4 v5, s[16:19], s32 offen sc1 lds
    s_add_u32 m0, m0, 1024
    s_add_u32 s32, s32, 32768
    buffer_load_dwordx4 v5, s[16:19], s32 offen sc1 lds
    s_add_u32 m0, m0, 1024
    s_add_u32 s32, s32, 32768
    buffer_load_dwordx4 v5, s[16:19], s32 offen sc1 lds
    s_add_u32 m0, m0, 1024
    s_add_u32 s32, s32, 32768
    buffer_load_dwordx4 v5, s[16:19], s32 offen sc1 lds
    s_add_u32 s32, s25, 2
    s_and_b32 s32, s32, 15
    s_lshl_b32 s32, s32, 17
    s_add_u32 s32, s32, s27
    s_add_u32 m0, s28, 32768
    s_nop 0
    buffer_load_dwordx4 v5, s[16:19], s32 offen sc1 lds
    s_add_u32 m0, m0, 1024
    s_add_u32 s32, s32, 32768
    buffer_load_dwordx4 v5, s[16:19], s32 offen sc1 lds
    s_add_u32 m0, m0, 1024
    s_add_u32 s32, s32, 32768
    buffer_load_dwordx4 v5, s[16:19], s32 offen sc1 lds
    s_add_u32 m0, m0, 1024
    s_add_u32 s32, s32, 32768
    buffer_load_dwordx4 v5, s[16:19], s32 offen sc1 lds
    s_waitcnt vmcnt(12)
    v_pk_add_f32 v[32:33], v[32:33], v[36:37]
    v_pk_add_f32 v[40:41], v[40:41], v[44:45]
    v_pk_add_f32 v[34:35], v[34:35], v[38:39]
    v_pk_add_f32 v[42:43], v[42:43], v[46:47]
    v_pk_add_f32 v[32:33], v[32:33], v[40:41]
    v_pk_add_f32 v[34:35], v[34:35], v[42:43]
    v_cvt_pk_bf16_f32 v36, v32, v33
    v_cvt_pk_bf16_f32 v37, v34, v35
    v_lshlrev_b32 v32, 16, v36
    v_and_b32 v33, s46, v36
    v_lshlrev_b32 v34, 16, v37
    v_and_b32 v35, s46, v37
    v_fma_f32 v32, v32, v21, v19
    v_fma_f32 v33, v33, v21, v19
    v_fma_f32 v34, v34, v21, v19
    v_fma_f32 v35, v35, v21, v19
    v_cvt_pk_bf16_f32 v36, v32, v33
    v_cvt_pk_bf16_f32 v37, v34, v35
    v_lshlrev_b32 v32, 16, v36
    v_and_b32 v33, s46, v36
    v_lshlrev_b32 v34, 16, v37
    v_and_b32 v35, s46, v37
    s_mov_b32 exec_hi, 0
    ds_write_b128 v18, v[32:35]
    s_not_b64 exec, exec
    ds_write_b64 v20, v[36:37]
    s_mov_b64 exec, -1
    s_waitcnt lgkmcnt(0)
    s_waitcnt vmcnt(4)
    s_barrier
    s_add_u32 s32, s25, 3
    s_and_b32 s32, s32, 15
    s_lshl_b32 s32, s32, 17
    s_add_u32 s32, s32, s27
    s_add_u32 m0, s28, 49152
    s_nop 0
    buffer_load_dwordx4 v5, s[16:19], s32 offen sc1 lds
    s_add_u32 m0, m0, 1024
    s_add_u32 s32, s32, 32768
    buffer_load_dwordx4 v5, s[16:19], s32 offen sc1 lds
    s_add_u32 m0, m0, 1024
    s_add_u32 s32, s32, 32768
    buffer_load_dwordx4 v5, s[16:19], s32 offen sc1 lds
    s_add_u32 m0, m0, 1024
    s_add_u32 s32, s32, 32768
    buffer_load_dwordx4 v5, s[16:19], s32 offen sc1 lds
    s_load_dwordx2 s[4:5], s[0:1], 64
    s_cmp_eq_u32 s38, 1
    s_cbranch_scc1 km_hz
    s_cmp_lg_u32 s23, 0
    s_cbranch_scc1 km_h_nq
    v_bfe_u32 v10, v1, 2, 2
    v_lshl_add_u32 v10, v4, 3, v10
    v_lshlrev_b32 v10, 7, v10
    v_bfe_u32 v11, v1, 4, 1
    v_lshl_add_u32 v10, v11, 5, v10
    v_and_b32 v11, 1, v1
    v_lshl_add_u32 v10, v11, 4, v10
    v_bfe_u32 v11, v1, 1, 1
    v_lshl_add_u32 v10, v11, 3, v10
    v_bfe_u32 v11, v1, 3, 1
    v_lshl_add_u32 v10, v11, 6, v10
    v_xor_b32 v11, 64, v10
    s_lshl_b32 s32, s26, 12
    s_add_u32 s32, s32, 74240
    v_add_u32 v10, s32, v10
    v_add_u32 v11, s32, v11
    v_lshlrev_b32 v12, 5, v4
    v_add_u32 v12, 147968, v12
    v_mov_b32 v14, 0
    v_mov_b32 v15, 0xbf803f80
    v_mov_b32 v16, v15
    v_mov_b32 v17, v15
    v_mov_b32 v18, v15
    v_mov_b32 v19, v15
    v_and_b32 v7, 0x13, v6
    v_and_b32 v9, 4, v6
    v_lshl_or_b32 v7, v9, 1, v7
    v_and_b32 v9, 8, v6
    v_lshrrev_b32 v9, 1, v9
    v_or_b32 v7, v7, v9
    s_add_u32 s32, s25, 0
    s_and_b32 s32, s32, 15
    s_lshl_b32 s32, s32, 5
    v_add_u32 v9, s32, v7
    v_lshlrev_b32 v152, 1, v9
    v_lshlrev_b32 v9, 2, v9
    v_add_u32 v9, 147968, v9
    v_add_u32 v152, 160768, v152
    ds_read_b32 v160, v9
    s_add_u32 s32, s25, 1
    s_and_b32 s32, s32, 15
    s_lshl_b32 s32, s32, 5
    v_add_u32 v9, s32, v7
    v_lshlrev_b32 v153, 1, v9
    v_lshlrev_b32 v9, 2, v9
    v_add_u32 v9, 147968, v9
    v_add_u32 v153, 160768, v153
    ds_read_b32 v161, v9
    s_add_u32 s32, s25, 2
    s_and_b32 s32, s32, 15
    s_lshl_b32 s32, s32, 5
    v_add_u32 v9, s32, v7
    v_lshlrev_b32 v154, 1, v9
    v_lshlrev_b32 v9, 2, v9
    v_add_u32 v9, 147968, v9
    v_add_u32 v154, 160768, v154
    ds_read_b32 v162, v9
    s_add_u32 s32, s25, 3
    s_and_b32 s32, s32, 15
    s_lshl_b32 s32, s32, 5
    v_add_u32 v9, s32, v7
    v_lshlrev_b32 v155, 1, v9
    v_lshlrev_b32 v9, 2, v9
    v_add_u32 v9, 147968, v9
    v_add_u32 v155, 160768, v155
    ds_read_b32 v163, v9
    s_add_u32 s32, s25, 8
    s_and_b32 s32, s32, 15
    s_lshl_b32 s32, s32, 5
    v_add_u32 v9, s32, v7
    v_lshlrev_b32 v156, 1, v9
    v_lshlrev_b32 v9, 2, v9
    v_add_u32 v9, 147968, v9
    v_add_u32 v156, 160768, v156
    ds_read_b32 v164, v9
    s_add_u32 s32, s25, 9
    s_and_b32 s32, s32, 15
    s_lshl_b32 s32, s32, 5
    v_add_u32 v9, s32, v7
    v_lshlrev_b32 v157, 1, v9
    v_lshlrev_b32 v9, 2, v9
    v_add_u32 v9, 147968, v9
    v_add_u32 v157, 160768, v157
    ds_read_b32 v165, v9
    s_add_u32 s32, s25, 10
    s_and_b32 s32, s32, 15
    s_lshl_b32 s32, s32, 5
    v_add_u32 v9, s32, v7
    v_lshlrev_b32 v158, 1, v9
    v_lshlrev_b32 v9, 2, v9
    v_add_u32 v9, 147968, v9
    v_add_u32 v158, 160768, v158
    ds_read_b32 v166, v9
    s_add_u32 s32, s25, 11
    s_and_b32 s32, s32, 15
    s_lshl_b32 s32, s32, 5
    v_add_u32 v9, s32, v7
    v_lshlrev_b32 v159, 1, v9
    v_lshlrev_b32 v9, 2, v9
    v_add_u32 v9, 147968, v9
    v_add_u32 v159, 160768, v159
    ds_read_b32 v167, v9
    s_waitcnt vmcnt(0)
    s_barrier
    ds_read_b64_tr_b16 v[24:25], v10 offset:0
    ds_read_b64_tr_b16 v[26:27], v10 offset:512
    ds_read_b64_tr_b16 v[28:29], v10 offset:2048
    ds_read_b64_tr_b16 v[30:31], v10 offset:2560
    ds_read_b64_tr_b16 v[32:33], v10 offset:16384
    ds_read_b64_tr_b16 v[34:35], v10 offset:16896
    ds_read_b64_tr_b16 v[36:37], v10 offset:18432
    ds_read_b64_tr_b16 v[38:39], v10 offset:18944
    ds_read_b64_tr_b16 v[40:41], v10 offset:32768
    ds_read_b64_tr_b16 v[42:43], v10 offset:33280
    ds_read_b64_tr_b16 v[44:45], v10 offset:34816
    ds_read_b64_tr_b16 v[46:47], v10 offset:35328
    ds_read_b64_tr_b16 v[48:49], v10 offset:49152
    ds_read_b64_tr_b16 v[50:51], v10 offset:49664
    ds_read_b64_tr_b16 v[52:53], v10 offset:51200
    ds_read_b64_tr_b16 v[54:55], v10 offset:51712
    ds_read_b64_tr_b16 v[56:57], v10 offset:8192
    ds_read_b64_tr_b16 v[58:59], v10 offset:8704
    ds_read_b64_tr_b16 v[60:61], v10 offset:10240
    ds_read_b64_tr_b16 v[62:63], v10 offset:10752
    ds_read_b64_tr_b16 v[64:65], v10 offset:24576
    ds_read_b64_tr_b16 v[66:67], v10 offset:25088
    ds_read_b64_tr_b16 v[68:69], v10 offset:26624
    ds_read_b64_tr_b16 v[70:71], v10 offset:27136
    ds_read_b64_tr_b16 v[72:73], v10 offset:40960
    ds_read_b64_tr_b16 v[74:75], v10 offset:41472
    ds_read_b64_tr_b16 v[76:77], v10 offset:43008
    ds_read_b64_tr_b16 v[78:79], v10 offset:43520
    ds_read_b64_tr_b16 v[80:81], v10 offset:57344
    ds_read_b64_tr_b16 v[82:83], v10 offset:57856
    ds_read_b64_tr_b16 v[84:85], v10 offset:59392
    ds_read_b64_tr_b16 v[86:87], v10 offset:59904
    s_waitcnt lgkmcnt(15)
    v_mfma_f32_32x32x16_bf16 v[88:103], v[16:19], v[24:27], 0
    v_mfma_f32_32x32x16_bf16 v[88:103], v[16:19], v[28:31], v[88:103]
    s_waitcnt lgkmcnt(15)
    v_mfma_f32_32x32x16_bf16 v[104:119], v[16:19], v[32:35], 0
    v_mfma_f32_32x32x16_bf16 v[104:119], v[16:19], v[36:39], v[104:119]
    s_waitcnt lgkmcnt(15)
    v_mfma_f32_32x32x16_bf16 v[120:135], v[16:19], v[40:43], 0
    v_mfma_f32_32x32x16_bf16 v[120:135], v[16:19], v[44:47], v[120:135]
    s_nop 5
    v_mul_f32 v20, v88, v160
    v_cvt_pk_bf16_f32 v160, v20, v20
    ds_write_b16 v152, v160
    s_waitcnt lgkmcnt(15)
    v_mfma_f32_32x32x16_bf16 v[88:103], v[16:19], v[48:51], 0
    v_mfma_f32_32x32x16_bf16 v[88:103], v[16:19], v[52:55], v[88:103]
    v_mul_f32 v20, v104, v161
    v_cvt_pk_bf16_f32 v161, v20, v20
    ds_write_b16 v153, v161
    s_waitcnt lgkmcnt(14)
    v_mfma_f32_32x32x16_bf16 v[104:119], v[16:19], v[56:59], 0
    v_mfma_f32_32x32x16_bf16 v[104:119], v[16:19], v[60:63], v[104:119]
    v_mul_f32 v20, v120, v162
    v_cvt_pk_bf16_f32 v162, v20, v20
    ds_write_b16 v154, v162
    s_waitcnt lgkmcnt(11)
    v_mfma_f32_32x32x16_bf16 v[120:135], v[16:19], v[64:67], 0
    v_mfma_f32_32x32x16_bf16 v[120:135], v[16:19], v[68:71], v[120:135]
    v_mul_f32 v20, v88, v163
    v_cvt_pk_bf16_f32 v163, v20, v20
    ds_write_b16 v155, v163
    s_waitcnt lgkmcnt(8)
    v_mfma_f32_32x32x16_bf16 v[88:103], v[16:19], v[72:75], 0
    v_mfma_f32_32x32x16_bf16 v[88:103], v[16:19], v[76:79], v[88:103]
    v_mul_f32 v20, v104, v164
    v_cvt_pk_bf16_f32 v164, v20, v20
    ds_write_b16 v156, v164
    s_waitcnt lgkmcnt(5)
    v_mfma_f32_32x32x16_bf16 v[104:119], v[16:19], v[80:83], 0
    v_mfma_f32_32x32x16_bf16 v[104:119], v[16:19], v[84:87], v[104:119]
    v_mul_f32 v20, v120, v165
    v_cvt_pk_bf16_f32 v165, v20, v20
    ds_write_b16 v157, v165
    s_nop 2
    v_mul_f32 v20, v88, v166
    v_cvt_pk_bf16_f32 v166, v20, v20
    ds_write_b16 v158, v166
    s_nop 2
    v_mul_f32 v20, v104, v167
    v_cvt_pk_bf16_f32 v167, v20, v20
    ds_write_b16 v159, v167
    s_waitcnt lgkmcnt(0)
    v_mov_b32 v8, 163360
    v_mov_b32 v9, 1
    s_mov_b64 exec, 1
    ds_add_u32 v8, v9
    s_mov_b64 exec, -1
    s_branch km_hw
km_h_nq:
    s_waitcnt vmcnt(0)
    s_barrier
    s_branch km_hw
km_hz:
    s_lshl_b32 s34, s37, 1
    s_add_u32 s34, s34, 2
    s_lshl_b32 s34, s34, 11
    buffer_load_dwordx4 v[32:35], v3, s[16:19], s34 offen offset:0 sc1
    buffer_load_dwordx4 v[36:39], v3, s[16:19], s34 offen offset:1024 sc1
    buffer_load_dwordx4 v[64:67], v3, s[16:19], s34 offen offset:2048 sc1
    buffer_load_dwordx4 v[68:71], v3, s[16:19], s34 offen offset:3072 sc1
    s_add_u32 s34, s34, 12288
    buffer_load_dwordx4 v[40:43], v3, s[16:19], s34 offen offset:0 sc1
    buffer_load_dwordx4 v[44:47], v3, s[16:19], s34 offen offset:1024 sc1
    buffer_load_dwordx4 v[72:75], v3, s[16:19], s34 offen offset:2048 sc1
    buffer_load_dwordx4 v[76:79], v3, s[16:19], s34 offen offset:3072 sc1
    s_add_u32 s34, s34, 12288
    buffer_load_dwordx4 v[48:51], v3, s[16:19], s34 offen offset:0 sc1
    buffer_load_dwordx4 v[52:55], v3, s[16:19], s34 offen offset:1024 sc1
    buffer_load_dwordx4 v[80:83], v3, s[16:19], s34 offen offset:2048 sc1
    buffer_load_dwordx4 v[84:87], v3, s[16:19], s34 offen offset:3072 sc1
    s_add_u32 s34, s34, 12288
    buffer_load_dwordx4 v[56:59], v3, s[16:19], s34 offen offset:0 sc1
    buffer_load_dwordx4 v[60:63], v3, s[16:19], s34 offen offset:1024 sc1
    buffer_load_dwordx4 v[88:91], v3, s[16:19], s34 offen offset:2048 sc1
    buffer_load_dwordx4 v[92:95], v3, s[16:19], s34 offen offset:3072 sc1
    s_waitcnt vmcnt(16)
    s_barrier
    s_load_dwordx2 s[40:41], s[0:1], 0
    v_mov_b32 v163, v6
    v_lshrrev_b32 v6, 2, v1
    v_lshlrev_b32 v164, 6, v6
    v_add_u32 v164, s23, v164
    v_subrev_u32 v8, 992, v164
    v_cmp_lt_u32 vcc, 15, v6
    s_cmp_eq_u32 s23, 0
    s_cselect_b64 vcc, vcc, 0
    v_cndmask_b32 v164, v164, v8, vcc
    s_cmp_eq_u32 s37, 1
    s_cselect_b64 s[58:59], -1, 0
    v_sub_u32 v8, 2048, v164
    v_cmp_eq_u32 vcc, 0, v164
    v_mov_b32 v9, 1024
    s_nop 0
    v_cndmask_b32 v8, v8, v9, vcc
    v_cndmask_b32 v164, v164, v8, s[58:59]
    v_lshlrev_b32 v164, 10, v164
    v_and_b32 v8, 3, v1
    v_lshl_add_u32 v164, v8, 4, v164
    v_lshrrev_b32 v6, 2, v1
    v_add_u32 v6, 16, v6
    v_lshlrev_b32 v165, 6, v6
    v_add_u32 v165, s23, v165
    v_subrev_u32 v8, 992, v165
    v_cmp_lt_u32 vcc, 15, v6
    s_cmp_eq_u32 s23, 0
    s_cselect_b64 vcc, vcc, 0
    v_cndmask_b32 v165, v165, v8, vcc
    s_cmp_eq_u32 s37, 1
    s_cselect_b64 s[58:59], -1, 0
    v_sub_u32 v8, 2048, v165
    v_cmp_eq_u32 vcc, 0, v165
    v_mov_b32 v9, 1024
    s_nop 0
    v_cndmask_b32 v8, v8, v9, vcc
    v_cndmask_b32 v165, v165, v8, s[58:59]
    v_lshlrev_b32 v165, 10, v165
    v_and_b32 v8, 3, v1
    v_lshl_add_u32 v165, v8, 4, v165
    v_mov_b32 v6, v163
    v_lshlrev_b32 v166, 6, v6
    v_add_u32 v166, s23, v166
    v_subrev_u32 v8, 992, v166
    v_cmp_lt_u32 vcc, 15, v6
    s_cmp_eq_u32 s23, 0
    s_cselect_b64 vcc, vcc, 0
    v_cndmask_b32 v166, v166, v8, vcc
    s_cmp_eq_u32 s37, 1
    s_cselect_b64 s[58:59], -1, 0
    v_sub_u32 v8, 2048, v166
    v_cmp_eq_u32 vcc, 0, v166
    v_mov_b32 v9, 1024
    s_nop 0
    v_cndmask_b32 v8, v8, v9, vcc
    v_cndmask_b32 v166, v166, v8, s[58:59]
    v_lshlrev_b32 v166, 10, v166
    s_lshl_b32 s30, s22, 6
    s_sub_u32 s31, 960, s30
    s_sub_u32 s33, 1024, s30
    s_and_b32 s33, s33, 511
    s_add_u32 s33, s33, 512
    s_lshl_b32 s32, s37, 12
    s_add_u32 s32, s32, 139776
    s_waitcnt lgkmcnt(0)
    s_mov_b32 s42, 0x200000
    s_mov_b32 s43, 0x20000
    s_add_u32 m0, s32, 0
    s_nop 0
    buffer_load_dwordx4 v164, s[40:43], s30 offen lds
    s_add_u32 m0, s32, 1024
    s_nop 0
    buffer_load_dwordx4 v165, s[40:43], s30 offen lds
    s_add_u32 m0, s32, 2048
    s_nop 0
    buffer_load_dwordx4 v164, s[40:43], s31 offen lds
    s_add_u32 m0, s32, 3072
    s_nop 0
    buffer_load_dwordx4 v165, s[40:43], s31 offen lds
    s_lshl_b32 s32, s37, 8
    s_add_u32 m0, s32, 156160
    s_nop 0
    buffer_load_dword v166, s[40:43], s33 offen lds
    s_waitcnt vmcnt(5)
    s_cmp_eq_u32 s37, 1
    s_cselect_b32 s35, 1.0, 0
    v_pk_add_f32 v[32:33], v[32:33], v[40:41]
    v_pk_add_f32 v[48:49], v[48:49], v[56:57]
    v_pk_add_f32 v[34:35], v[34:35], v[42:43]
    v_pk_add_f32 v[50:51], v[50:51], v[58:59]
    v_pk_add_f32 v[36:37], v[36:37], v[44:45]
    v_pk_add_f32 v[52:53], v[52:53], v[60:61]
    v_pk_add_f32 v[38:39], v[38:39], v[46:47]
    v_pk_add_f32 v[54:55], v[54:55], v[62:63]
    v_pk_add_f32 v[32:33], v[32:33], v[48:49]
    v_pk_add_f32 v[34:35], v[34:35], v[50:51]
    v_pk_add_f32 v[36:37], v[36:37], v[52:53]
    v_pk_add_f32 v[38:39], v[38:39], v[54:55]
    v_cvt_pk_bf16_f32 v40, v32, v33
    v_cvt_pk_bf16_f32 v41, v34, v35
    v_cvt_pk_bf16_f32 v42, v36, v37
    v_cvt_pk_bf16_f32 v43, v38, v39
    v_pk_add_f32 v[64:65], v[64:65], v[72:73]
    v_pk_add_f32 v[80:81], v[80:81], v[88:89]
    v_pk_add_f32 v[66:67], v[66:67], v[74:75]
    v_pk_add_f32 v[82:83], v[82:83], v[90:91]
    v_pk_add_f32 v[68:69], v[68:69], v[76:77]
    v_pk_add_f32 v[84:85], v[84:85], v[92:93]
    v_pk_add_f32 v[70:71], v[70:71], v[78:79]
    v_pk_add_f32 v[86:87], v[86:87], v[94:95]
    v_pk_add_f32 v[64:65], v[64:65], v[80:81]
    v_pk_add_f32 v[66:67], v[66:67], v[82:83]
    v_pk_add_f32 v[68:69], v[68:69], v[84:85]
    v_pk_add_f32 v[70:71], v[70:71], v[86:87]
    v_cvt_pk_bf16_f32 v72, v64, v65
    v_cvt_pk_bf16_f32 v73, v66, v67
    v_cvt_pk_bf16_f32 v74, v68, v69
    v_cvt_pk_bf16_f32 v75, v70, v71
    v_lshlrev_b32 v32, 16, v40
    v_and_b32 v33, s46, v40
    v_lshlrev_b32 v34, 16, v41
    v_and_b32 v35, s46, v41
    v_lshlrev_b32 v36, 16, v42
    v_and_b32 v37, s46, v42
    v_lshlrev_b32 v38, 16, v43
    v_and_b32 v39, s46, v43
    v_add_f32 v32, s35, v32
    v_add_f32 v33, s35, v33
    v_add_f32 v34, s35, v34
    v_add_f32 v35, s35, v35
    v_add_f32 v36, s35, v36
    v_add_f32 v37, s35, v37
    v_add_f32 v38, s35, v38
    v_add_f32 v39, s35, v39
    v_cvt_pk_bf16_f32 v40, v32, v33
    v_cvt_pk_bf16_f32 v41, v34, v35
    v_cvt_pk_bf16_f32 v42, v36, v37
    v_cvt_pk_bf16_f32 v43, v38, v39
    v_lshlrev_b32 v32, 16, v40
    v_and_b32 v33, s46, v40
    v_lshlrev_b32 v34, 16, v41
    v_and_b32 v35, s46, v41
    v_lshlrev_b32 v36, 16, v42
    v_and_b32 v37, s46, v42
    v_lshlrev_b32 v38, 16, v43
    v_and_b32 v39, s46, v43
    s_lshl_b32 s33, s37, 11
    s_add_u32 s33, s33, 150016
    v_add_u32 v8, s33, v3
    ds_write_b128 v8, v[32:35]
    ds_write_b128 v8, v[36:39] offset:1024
    s_lshl_b32 s33, s37, 10
    s_add_u32 s33, s33, 157696
    v_lshl_add_u32 v20, v1, 3, s33
    ds_write_b64 v20, v[72:73]
    ds_write_b64 v20, v[74:75] offset:512
    s_cmp_eq_u32 s37, 0
    s_cbranch_scc1 km_nochk
    v_subrev_u32 v20, 2048, v20
    ds_write_b64 v20, v[40:41]
    ds_write_b64 v20, v[42:43] offset:512
km_nochk:
    s_waitcnt vmcnt(0) lgkmcnt(0)
    v_mov_b32 v8, 163332
    v_mov_b32 v9, 1
    s_mov_b64 exec, 1
    ds_add_u32 v8, v9
    s_mov_b64 exec, -1
    s_cmp_eq_u32 s37, 1
    s_cselect_b32 s40, s10, s8
    s_cselect_b32 s41, s11, s9
    s_mov_b32 s42, 1835008
    s_mov_b32 s43, 0x20000
    v_lshrrev_b32 v140, 3, v1
    v_bfe_u32 v141, v1, 1, 2
    v_and_b32 v142, 2, v140
    v_or_b32 v142, s37, v142
    v_xor_b32 v141, v141, v142
    v_lshlrev_b32 v141, 5, v141
    v_and_b32 v142, 1, v1
    v_lshl_add_u32 v141, v142, 4, v141
    v_mul_u32_u24 v142, 3584, v140
    v_add_u32 v144, v142, v141
    v_sub_u32 v142, 942592, v142
    v_add_u32 v145, v142, v141
    v_subrev_u32 v146, 917504, v145
    v_cmp_eq_u32 vcc, 0, v140
    s_nop 1
    v_cndmask_b32 v146, v145, v146, vcc
    s_lshl_b32 s30, s48, 7
    s_branch km_hw2
km_hw:
    s_mov_b32 s24, 0
km_hw_p1:
    s_lshr_b32 s33, s24, 1
    s_lshl_b32 s31, s33, 13
    s_add_u32 s33, s33, s50
    s_and_b32 s33, s33, 15
    s_lshl_b32 s33, s33, 5
    s_and_b32 s34, s24, 1
    s_lshl_b32 s35, s34, 11
    s_add_u32 s31, s31, s35
    s_lshl_b32 s35, s37, 12
    s_add_u32 m0, s31, s35
    s_lshl_b32 s34, s34, 4
    s_add_u32 s33, s33, s34
    s_cmp_ge_u32 s33, 256
    s_cbranch_scc1 km_hw_p1_up
    s_mul_i32 s33, s33, 3584
    s_add_u32 s33, s33, s30
    s_add_u32 s34, s33, 28672
    buffer_load_dwordx4 v144, s[40:43], s33 offen lds
    s_add_u32 m0, m0, 1024
    s_nop 0
    buffer_load_dwordx4 v144, s[40:43], s34 offen lds
    s_branch km_hw_p1_nx
km_hw_p1_up:
    s_cmp_eq_u32 s33, 256
    s_cselect_b64 vcc, -1, 0
    v_cndmask_b32 v147, v145, v146, vcc
    s_sub_u32 s33, 505, s33
    s_mul_i32 s33, s33, 3584
    s_add_u32 s33, s33, s30
    s_sub_u32 s34, s33, 28672
    buffer_load_dwordx4 v147, s[40:43], s33 offen lds
    s_add_u32 m0, m0, 1024
    s_nop 0
    buffer_load_dwordx4 v145, s[40:43], s34 offen lds
km_hw_p1_nx:
    s_add_u32 s24, s24, 1
    s_cmp_lt_u32 s24, 18
    s_cbranch_scc1 km_hw_p1
    s_waitcnt vmcnt(0)
    v_mov_b32 v8, 163344
    v_mov_b32 v9, 1
    s_mov_b64 exec, 1
    ds_add_u32 v8, v9
    s_mov_b64 exec, -1
km_hw2:
    s_waitcnt lgkmcnt(0)
    s_mov_b32 s12, s4
    s_mov_b32 s13, s5
    s_mov_b32 s14, 0x1c0000
    s_mov_b32 s15, 0x20000
    s_cmp_ge_u32 s21, 28
    s_cselect_b32 s32, 36, 0
    s_cselect_b32 s33, 4, 4
    s_add_u32 s32, s32, 163328
    v_mov_b32 v8, s32
    s_mov_b32 s57, 0
km_spinT:
    ds_read_b32 v9, v8 offset:0
    s_waitcnt lgkmcnt(0)
    v_readfirstlane_b32 s56, v9
    s_nop 0
    s_cmp_ge_u32 s56, s33
    s_cbranch_scc1 km_spinT_ok
    s_sleep 1
    s_add_u32 s57, s57, 1
    s_cmp_lt_u32 s57, 2097152
    s_cbranch_scc1 km_spinT
km_spinT_ok:
    s_add_u32 s24, s38, 18
km_hw_p2:
    s_lshr_b32 s33, s24, 1
    s_lshl_b32 s31, s33, 13
    s_add_u32 s33, s33, s50
    s_and_b32 s33, s33, 15
    s_lshl_b32 s33, s33, 5
    s_and_b32 s34, s24, 1
    s_lshl_b32 s35, s34, 11
    s_add_u32 s31, s31, s35
    s_lshl_b32 s35, s37, 12
    s_add_u32 m0, s31, s35
    s_lshl_b32 s34, s34, 4
    s_add_u32 s33, s33, s34
    s_cmp_ge_u32 s33, 256
    s_cbranch_scc1 km_hw_p2_up
    s_mul_i32 s33, s33, 3584
    s_add_u32 s33, s33, s30
    s_add_u32 s34, s33, 28672
    buffer_load_dwordx4 v144, s[40:43], s33 offen lds
    s_add_u32 m0, m0, 1024
    s_nop 0
    buffer_load_dwordx4 v144, s[40:43], s34 offen lds
    s_branch km_hw_p2_nx
km_hw_p2_up:
    s_cmp_eq_u32 s33, 256
    s_cselect_b64 vcc, -1, 0
    v_cndmask_b32 v147, v145, v146, vcc
    s_sub_u32 s33, 505, s33
    s_mul_i32 s33, s33, 3584
    s_add_u32 s33, s33, s30
    s_sub_u32 s34, s33, 28672
    buffer_load_dwordx4 v147, s[40:43], s33 offen lds
    s_add_u32 m0, m0, 1024
    s_nop 0
    buffer_load_dwordx4 v145, s[40:43], s34 offen lds
km_hw_p2_nx:
    s_add_u32 s24, s24, 2
    s_cmp_lt_u32 s24, 32
    s_cbranch_scc1 km_hw_p2
    s_waitcnt vmcnt(0)
    v_mov_b32 v8, 163348
    v_mov_b32 v9, 1
    s_mov_b64 exec, 1
    ds_add_u32 v8, v9
    s_mov_b64 exec, -1
    s_setprio 0
    s_and_b32 s51, s21, 3
    s_lshr_b32 s52, s21, 2
    s_lshl_b32 s53, s20, 2
    s_add_u32 s53, s53, s51
    s_lshl_b32 s54, s51, 1
    s_add_u32 s54, s54, s52
    s_and_b32 s54, s54, 7
    s_cmp_eq_u32 s54, 7
    s_cselect_b32 s54, 3, s54
    v_lshrrev_b32 v5, 3, v1
    v_and_b32 v7, 7, v1
    v_lshrrev_b32 v8, 2, v1
    v_and_b32 v8, 4, v8
    v_xor_b32 v7, v7, v8
    v_lshlrev_b32 v5, 10, v5
    v_lshl_add_u32 v5, v7, 4, v5
    s_mul_i32 s27, s26, 458752
    s_lshl_b32 s28, s52, 7
    s_add_u32 s27, s27, s28
    s_lshl_b32 s28, s26, 13
    v_add_u32 v7, s28, v3
    v_add_u32 v10, 65536, v7
    s_lshl_b32 s32, s26, 2
    s_add_u32 s32, s32, 163392
    v_mov_b32 v11, s32
    v_mov_b32 v12, 1
    v_mov_b32 v8, 163376
    s_mov_b32 s57, 0
km_spinP0:
    ds_read_b32 v9, v8
    s_waitcnt lgkmcnt(0)
    v_readfirstlane_b32 s56, v9
    s_nop 0
    s_cmp_ge_u32 s56, 8
    s_cbranch_scc1 km_spinP0_ok
    s_sleep 6
    s_add_u32 s57, s57, 1
    s_cmp_lt_u32 s57, 2097152
    s_cbranch_scc1 km_spinP0
km_spinP0_ok:
    s_add_u32 s32, s54, 0
    s_sub_u32 s25, s32, 7
    s_cmp_ge_u32 s32, 7
    s_cselect_b32 s32, s25, s32
    s_lshl_b32 s32, s32, 16
    s_add_u32 s32, s32, s27
    s_add_u32 m0, s28, 0
    s_nop 0
    buffer_load_dwordx4 v5, s[12:15], s32 offen lds
    s_add_u32 m0, m0, 1024
    s_add_u32 s32, s32, 8192
    buffer_load_dwordx4 v5, s[12:15], s32 offen lds
    s_add_u32 m0, m0, 1024
    s_add_u32 s32, s32, 8192
    buffer_load_dwordx4 v5, s[12:15], s32 offen lds
    s_add_u32 m0, m0, 1024
    s_add_u32 s32, s32, 8192
    buffer_load_dwordx4 v5, s[12:15], s32 offen lds
    s_add_u32 m0, m0, 1024
    s_add_u32 s32, s32, 8192
    buffer_load_dwordx4 v5, s[12:15], s32 offen lds
    s_add_u32 m0, m0, 1024
    s_add_u32 s32, s32, 8192
    buffer_load_dwordx4 v5, s[12:15], s32 offen lds
    s_add_u32 m0, m0, 1024
    s_add_u32 s32, s32, 8192
    buffer_load_dwordx4 v5, s[12:15], s32 offen lds
    s_add_u32 m0, m0, 1024
    s_add_u32 s32, s32, 8192
    buffer_load_dwordx4 v5, s[12:15], s32 offen lds
    s_add_u32 s32, s54, 4
    s_sub_u32 s25, s32, 7
    s_cmp_ge_u32 s32, 7
    s_cselect_b32 s32, s25, s32
    s_lshl_b32 s32, s32, 16
    s_add_u32 s32, s32, s27
    buffer_load_dwordx4 v[16:19], v5, s[12:15], s32 offen
    s_add_u32 s32, s32, 8192
    buffer_load_dwordx4 v[20:23], v5, s[12:15], s32 offen
    s_add_u32 s32, s32, 8192
    buffer_load_dwordx4 v[24:27], v5, s[12:15], s32 offen
    s_add_u32 s32, s32, 8192
    buffer_load_dwordx4 v[28:31], v5, s[12:15], s32 offen
    s_add_u32 s32, s32, 8192
    buffer_load_dwordx4 v[32:35], v5, s[12:15], s32 offen
    s_add_u32 s32, s32, 8192
    buffer_load_dwordx4 v[36:39], v5, s[12:15], s32 offen
    s_add_u32 s32, s32, 8192
    buffer_load_dwordx4 v[40:43], v5, s[12:15], s32 offen
    s_add_u32 s32, s32, 8192
    buffer_load_dwordx4 v[44:47], v5, s[12:15], s32 offen
    s_waitcnt vmcnt(8)
    s_mov_b64 exec, 1
    ds_add_u32 v11, v12 offset:0
    s_mov_b64 exec, -1
    v_mov_b32 v8, 163380
    s_mov_b32 s57, 0
km_spinP1:
    ds_read_b32 v9, v8
    s_waitcnt lgkmcnt(0)
    v_readfirstlane_b32 s56, v9
    s_nop 0
    s_cmp_ge_u32 s56, 8
    s_cbranch_scc1 km_spinP1_ok
    s_sleep 6
    s_add_u32 s57, s57, 1
    s_cmp_lt_u32 s57, 2097152
    s_cbranch_scc1 km_spinP1
km_spinP1_ok:
    s_add_u32 s32, s54, 1
    s_sub_u32 s25, s32, 7
    s_cmp_ge_u32 s32, 7
    s_cselect_b32 s32, s25, s32
    s_lshl_b32 s32, s32, 16
    s_add_u32 s32, s32, s27
    s_add_u32 m0, s28, 32768
    s_nop 0
    buffer_load_dwordx4 v5, s[12:15], s32 offen lds
    s_add_u32 m0, m0, 1024
    s_add_u32 s32, s32, 8192
    buffer_load_dwordx4 v5, s[12:15], s32 offen lds
    s_add_u32 m0, m0, 1024
    s_add_u32 s32, s32, 8192
    buffer_load_dwordx4 v5, s[12:15], s32 offen lds
    s_add_u32 m0, m0, 1024
    s_add_u32 s32, s32, 8192
    buffer_load_dwordx4 v5, s[12:15], s32 offen lds
    s_add_u32 m0, m0, 1024
    s_add_u32 s32, s32, 8192
    buffer_load_dwordx4 v5, s[12:15], s32 offen lds
    s_add_u32 m0, m0, 1024
    s_add_u32 s32, s32, 8192
    buffer_load_dwordx4 v5, s[12:15], s32 offen lds
    s_add_u32 m0, m0, 1024
    s_add_u32 s32, s32, 8192
    buffer_load_dwordx4 v5, s[12:15], s32 offen lds
    s_add_u32 m0, m0, 1024
    s_add_u32 s32, s32, 8192
    buffer_load_dwordx4 v5, s[12:15], s32 offen lds
    s_add_u32 s32, s54, 5
    s_sub_u32 s25, s32, 7
    s_cmp_ge_u32 s32, 7
    s_cselect_b32 s32, s25, s32
    s_lshl_b32 s32, s32, 16
    s_add_u32 s32, s32, s27
    buffer_load_dwordx4 v[48:51], v5, s[12:15], s32 offen
    s_add_u32 s32, s32, 8192
    buffer_load_dwordx4 v[52:55], v5, s[12:15], s32 offen
    s_add_u32 s32, s32, 8192
    buffer_load_dwordx4 v[56:59], v5, s[12:15], s32 offen
    s_add_u32 s32, s32, 8192
    buffer_load_dwordx4 v[60:63], v5, s[12:15], s32 offen
    s_add_u32 s32, s32, 8192
    buffer_load_dwordx4 v[64:67], v5, s[12:15], s32 offen
    s_add_u32 s32, s32, 8192
    buffer_load_dwordx4 v[68:71], v5, s[12:15], s32 offen
    s_add_u32 s32, s32, 8192
    buffer_load_dwordx4 v[72:75], v5, s[12:15], s32 offen
    s_add_u32 s32, s32, 8192
    buffer_load_dwordx4 v[76:79], v5, s[12:15], s32 offen
    s_waitcnt vmcnt(8)
    s_mov_b64 exec, 1
    ds_add_u32 v11, v12 offset:0
    s_mov_b64 exec, -1
    v_mov_b32 v8, 163384
    s_mov_b32 s57, 0
km_spinP2:
    ds_read_b32 v9, v8
    s_waitcnt lgkmcnt(0)
    v_readfirstlane_b32 s56, v9
    s_nop 0
    s_cmp_ge_u32 s56, 8
    s_cbranch_scc1 km_spinP2_ok
    s_sleep 6
    s_add_u32 s57, s57, 1
    s_cmp_lt_u32 s57, 2097152
    s_cbranch_scc1 km_spinP2
km_spinP2_ok:
    s_add_u32 s32, s54, 2
    s_sub_u32 s25, s32, 7
    s_cmp_ge_u32 s32, 7
    s_cselect_b32 s32, s25, s32
    s_lshl_b32 s32, s32, 16
    s_add_u32 s32, s32, s27
    s_add_u32 m0, s28, 65536
    s_nop 0
    buffer_load_dwordx4 v5, s[12:15], s32 offen lds
    s_add_u32 m0, m0, 1024
    s_add_u32 s32, s32, 8192
    buffer_load_dwordx4 v5, s[12:15], s32 offen lds
    s_add_u32 m0, m0, 1024
    s_add_u32 s32, s32, 8192
    buffer_load_dwordx4 v5, s[12:15], s32 offen lds
    s_add_u32 m0, m0, 1024
    s_add_u32 s32, s32, 8192
    buffer_load_dwordx4 v5, s[12:15], s32 offen lds
    s_add_u32 m0, m0, 1024
    s_add_u32 s32, s32, 8192
    buffer_load_dwordx4 v5, s[12:15], s32 offen lds
    s_add_u32 m0, m0, 1024
    s_add_u32 s32, s32, 8192
    buffer_load_dwordx4 v5, s[12:15], s32 offen lds
    s_add_u32 m0, m0, 1024
    s_add_u32 s32, s32, 8192
    buffer_load_dwordx4 v5, s[12:15], s32 offen lds
    s_add_u32 m0, m0, 1024
    s_add_u32 s32, s32, 8192
    buffer_load_dwordx4 v5, s[12:15], s32 offen lds
    s_add_u32 s32, s54, 6
    s_sub_u32 s25, s32, 7
    s_cmp_ge_u32 s32, 7
    s_cselect_b32 s32, s25, s32
    s_lshl_b32 s32, s32, 16
    s_add_u32 s32, s32, s27
    buffer_load_dwordx4 v[80:83], v5, s[12:15], s32 offen
    s_add_u32 s32, s32, 8192
    buffer_load_dwordx4 v[84:87], v5, s[12:15], s32 offen
    s_add_u32 s32, s32, 8192
    buffer_load_dwordx4 v[88:91], v5, s[12:15], s32 offen
    s_add_u32 s32, s32, 8192
    buffer_load_dwordx4 v[92:95], v5, s[12:15], s32 offen
    s_add_u32 s32, s32, 8192
    buffer_load_dwordx4 v[96:99], v5, s[12:15], s32 offen
    s_add_u32 s32, s32, 8192
    buffer_load_dwordx4 v[100:103], v5, s[12:15], s32 offen
    s_add_u32 s32, s32, 8192
    buffer_load_dwordx4 v[104:107], v5, s[12:15], s32 offen
    s_add_u32 s32, s32, 8192
    buffer_load_dwordx4 v[108:111], v5, s[12:15], s32 offen
    s_waitcnt vmcnt(8)
    s_mov_b64 exec, 1
    ds_add_u32 v11, v12 offset:0
    s_mov_b64 exec, -1
    v_mov_b32 v8, 163388
    s_mov_b32 s57, 0
km_spinP3:
    ds_read_b32 v9, v8
    s_waitcnt lgkmcnt(0)
    v_readfirstlane_b32 s56, v9
    s_nop 0
    s_cmp_ge_u32 s56, 8
    s_cbranch_scc1 km_spinP3_ok
    s_sleep 6
    s_add_u32 s57, s57, 1
    s_cmp_lt_u32 s57, 2097152
    s_cbranch_scc1 km_spinP3
km_spinP3_ok:
    s_add_u32 s32, s54, 3
    s_sub_u32 s25, s32, 7
    s_cmp_ge_u32 s32, 7
    s_cselect_b32 s32, s25, s32
    s_lshl_b32 s32, s32, 16
    s_add_u32 s32, s32, s27
    s_add_u32 m0, s28, 98304
    s_nop 0
    buffer_load_dwordx4 v5, s[12:15], s32 offen lds
    s_add_u32 m0, m0, 1024
    s_add_u32 s32, s32, 8192
    buffer_load_dwordx4 v5, s[12:15], s32 offen lds
    s_add_u32 m0, m0, 1024
    s_add_u32 s32, s32, 8192
    buffer_load_dwordx4 v5, s[12:15], s32 offen lds
    s_add_u32 m0, m0, 1024
    s_add_u32 s32, s32, 8192
    buffer_load_dwordx4 v5, s[12:15], s32 offen lds
    s_add_u32 m0, m0, 1024
    s_add_u32 s32, s32, 8192
    buffer_load_dwordx4 v5, s[12:15], s32 offen lds
    s_add_u32 m0, m0, 1024
    s_add_u32 s32, s32, 8192
    buffer_load_dwordx4 v5, s[12:15], s32 offen lds
    s_add_u32 m0, m0, 1024
    s_add_u32 s32, s32, 8192
    buffer_load_dwordx4 v5, s[12:15], s32 offen lds
    s_add_u32 m0, m0, 1024
    s_add_u32 s32, s32, 8192
    buffer_load_dwordx4 v5, s[12:15], s32 offen lds
    s_waitcnt vmcnt(0)
    s_mov_b64 exec, 1
    ds_add_u32 v11, v12 offset:0
    s_mov_b64 exec, -1
    s_setprio 3
    s_mov_b32 s57, 0
km_spinFA0:
    ds_read_b32 v9, v11 offset:16
    s_waitcnt lgkmcnt(0)
    v_readfirstlane_b32 s56, v9
    s_nop 0
    s_cmp_ge_u32 s56, 1
    s_cbranch_scc1 km_spinFA0_ok
    s_sleep 2
    s_add_u32 s57, s57, 1
    s_cmp_lt_u32 s57, 2097152
    s_cbranch_scc1 km_spinFA0
km_spinFA0_ok:
    s_mov_b32 s57, 0
km_spinFB0:
    ds_read_b32 v9, v11 offset:48
    s_waitcnt lgkmcnt(0)
    v_readfirstlane_b32 s56, v9
    s_nop 0
    s_cmp_ge_u32 s56, 1
    s_cbranch_scc1 km_spinFB0_ok
    s_sleep 2
    s_add_u32 s57, s57, 1
    s_cmp_lt_u32 s57, 2097152
    s_cbranch_scc1 km_spinFB0
km_spinFB0_ok:
    ds_write_b128 v7, v[16:19] offset:0
    ds_write_b128 v7, v[20:23] offset:1024
    ds_write_b128 v7, v[24:27] offset:2048
    ds_write_b128 v7, v[28:31] offset:3072
    ds_write_b128 v7, v[32:35] offset:4096
    ds_write_b128 v7, v[36:39] offset:5120
    ds_write_b128 v7, v[40:43] offset:6144
    ds_write_b128 v7, v[44:47] offset:7168
    s_waitcnt lgkmcnt(0)
    s_mov_b64 exec, 1
    ds_add_u32 v11, v12 offset:0
    s_mov_b64 exec, -1
    s_mov_b32 s57, 0
km_spinFA1:
    ds_read_b32 v9, v11 offset:16
    s_waitcnt lgkmcnt(0)
    v_readfirstlane_b32 s56, v9
    s_nop 0
    s_cmp_ge_u32 s56, 2
    s_cbranch_scc1 km_spinFA1_ok
    s_sleep 2
    s_add_u32 s57, s57, 1
    s_cmp_lt_u32 s57, 2097152
    s_cbranch_scc1 km_spinFA1
km_spinFA1_ok:
    s_mov_b32 s57, 0
km_spinFB1:
    ds_read_b32 v9, v11 offset:48
    s_waitcnt lgkmcnt(0)
    v_readfirstlane_b32 s56, v9
    s_nop 0
    s_cmp_ge_u32 s56, 2
    s_cbranch_scc1 km_spinFB1_ok
    s_sleep 2
    s_add_u32 s57, s57, 1
    s_cmp_lt_u32 s57, 2097152
    s_cbranch_scc1 km_spinFB1
km_spinFB1_ok:
    ds_write_b128 v7, v[48:51] offset:32768
    ds_write_b128 v7, v[52:55] offset:33792
    ds_write_b128 v7, v[56:59] offset:34816
    ds_write_b128 v7, v[60:63] offset:35840
    ds_write_b128 v7, v[64:67] offset:36864
    ds_write_b128 v7, v[68:71] offset:37888
    ds_write_b128 v7, v[72:75] offset:38912
    ds_write_b128 v7, v[76:79] offset:39936
    s_waitcnt lgkmcnt(0)
    s_mov_b64 exec, 1
    ds_add_u32 v11, v12 offset:0
    s_mov_b64 exec, -1
    s_mov_b32 s57, 0
km_spinFA2:
    ds_read_b32 v9, v11 offset:16
    s_waitcnt lgkmcnt(0)
    v_readfirstlane_b32 s56, v9
    s_nop 0
    s_cmp_ge_u32 s56, 3
    s_cbranch_scc1 km_spinFA2_ok
    s_sleep 2
    s_add_u32 s57, s57, 1
    s_cmp_lt_u32 s57, 2097152
    s_cbranch_scc1 km_spinFA2
km_spinFA2_ok:
    s_mov_b32 s57, 0
km_spinFB2:
    ds_read_b32 v9, v11 offset:48
    s_waitcnt lgkmcnt(0)
    v_readfirstlane_b32 s56, v9
    s_nop 0
    s_cmp_ge_u32 s56, 3
    s_cbranch_scc1 km_spinFB2_ok
    s_sleep 2
    s_add_u32 s57, s57, 1
    s_cmp_lt_u32 s57, 2097152
    s_cbranch_scc1 km_spinFB2
km_spinFB2_ok:
    ds_write_b128 v10, v[80:83] offset:0
    ds_write_b128 v10, v[84:87] offset:1024
    ds_write_b128 v10, v[88:91] offset:2048
    ds_write_b128 v10, v[92:95] offset:3072
    ds_write_b128 v10, v[96:99] offset:4096
    ds_write_b128 v10, v[100:103] offset:5120
    ds_write_b128 v10, v[104:107] offset:6144
    ds_write_b128 v10, v[108:111] offset:7168
    s_waitcnt lgkmcnt(0)
    s_mov_b64 exec, 1
    ds_add_u32 v11, v12 offset:0
    s_mov_b64 exec, -1
    s_branch adaLN_cond__spectral_fnet__geglu_ffn__prompt_kernel_end
km_compute:
    s_lshr_b32 s27, s3, 2
    s_load_dwordx2 s[8:9], s[0:1], 88
    v_lshlrev_b32 v7, 6, v6
    v_add_u32 v7, s23, v7
    v_subrev_u32 v8, 992, v7
    v_cmp_lt_u32 vcc, 15, v6
    s_cmp_eq_u32 s23, 0
    s_cselect_b64 vcc, vcc, 0
    v_cndmask_b32 v7, v7, v8, vcc
    s_mov_b64 s[30:31], vcc
    s_lshr_b32 s28, s26, 1
    s_and_b32 s29, s26, 1
    s_lshl_b32 s29, s29, 4
    v_lshl_add_u32 v8, v4, 3, s29
    s_cmp_eq_u32 s23, 0
    s_cselect_b32 s32, 0, s28
    s_sub_i32 s32, s32, s27
    v_cvt_f32_i32 v9, s32
    v_mul_f32 v9, 0x3e800000, v9
    v_mul_u32_u24 v12, v7, v8
    v_and_b32 v12, 2047, v12
    v_cvt_f32_u32 v12, v12
    v_cvt_f32_u32 v13, v7
    v_mul_f32 v13, 0x3a000000, v13
    v_fmamk_f32 v64, v12, 0x3a000000, v9
    v_add_f32 v65, v64, v13
    v_add_f32 v66, v65, v13
    v_add_f32 v67, v66, v13
    v_add_f32 v68, v67, v13
    v_add_f32 v69, v68, v13
    v_add_f32 v70, v69, v13
    v_add_f32 v71, v70, v13
    v_cos_f32 v64, v64
    v_cos_f32 v65, v65
    v_cos_f32 v66, v66
    v_cos_f32 v67, v67
    v_cos_f32 v68, v68
    v_cos_f32 v69, v69
    v_cos_f32 v70, v70
    v_cos_f32 v71, v71
    v_cvt_pk_bf16_f32 v72, v64, v65
    v_cvt_pk_bf16_f32 v73, v66, v67
    v_cvt_pk_bf16_f32 v74, v68, v69
    v_cvt_pk_bf16_f32 v75, v70, v71
    s_not_b64 s[32:33], s[30:31]
    s_cmp_eq_u32 s28, 1
    s_cselect_b64 s[32:33], s[30:31], s[32:33]
    s_cmp_eq_u32 s23, 0
    s_cselect_b64 s[32:33], s[32:33], -1
    v_cndmask_b32 v72, 0, v72, s[32:33]
    v_cndmask_b32 v73, 0, v73, s[32:33]
    v_cndmask_b32 v74, 0, v74, s[32:33]
    v_cndmask_b32 v75, 0, v75, s[32:33]
    s_lshl_b32 s32, s3, 10
    s_add_u32 s32, s32, 139776
    v_add_u32 v8, s32, v3
    ds_write_b128 v8, v[72:75]
    s_cmp_eq_u32 s27, 1
    s_cselect_b32 s34, 0xbe800000, 0
    v_and_b32 v9, 0x13, v6
    v_and_b32 v10, 4, v6
    v_lshl_or_b32 v9, v10, 1, v9
    v_and_b32 v10, 8, v6
    v_lshrrev_b32 v10, 1, v10
    v_or_b32 v9, v9, v10
    s_lshl_b32 s32, s22, 5
    v_add_u32 v9, s32, v9
    s_lshl_b32 s32, s25, 5
    v_lshl_add_u32 v8, v4, 3, s32
    v_mul_u32_u24 v12, v9, v8
    v_and_b32 v12, 511, v12
    v_cvt_f32_u32 v12, v12
    v_cvt_f32_u32 v13, v9
    v_mul_f32 v13, 0x3b000000, v13
    v_mov_b32 v64, s34
    v_fmac_f32 v64, 0x3b000000, v12
    v_mul_f32 v10, 0x41800000, v13
    v_add_f32 v65, v64, v13
    v_add_f32 v66, v65, v13
    v_add_f32 v67, v66, v13
    v_add_f32 v68, v67, v13
    v_add_f32 v69, v68, v13
    v_add_f32 v70, v69, v13
    v_add_f32 v71, v70, v13
    v_add_f32 v72, v64, v10
    v_add_f32 v73, v65, v10
    v_add_f32 v74, v66, v10
    v_add_f32 v75, v67, v10
    v_add_f32 v76, v68, v10
    v_add_f32 v77, v69, v10
    v_add_f32 v78, v70, v10
    v_add_f32 v79, v71, v10
    v_cos_f32 v10, v10
    v_cos_f32 v64, v64
    v_cos_f32 v65, v65
    v_cos_f32 v66, v66
    v_cos_f32 v67, v67
    v_cos_f32 v68, v68
    v_cos_f32 v69, v69
    v_cos_f32 v70, v70
    v_cos_f32 v71, v71
    v_cos_f32 v72, v72
    v_cos_f32 v73, v73
    v_cos_f32 v74, v74
    v_cos_f32 v75, v75
    v_cos_f32 v76, v76
    v_cos_f32 v77, v77
    v_cos_f32 v78, v78
    v_cos_f32 v79, v79
    v_add_f32 v10, v10, v10
    v_cvt_pk_bf16_f32 v16, v64, v65
    v_cvt_pk_bf16_f32 v17, v66, v67
    v_cvt_pk_bf16_f32 v18, v68, v69
    v_cvt_pk_bf16_f32 v19, v70, v71
    v_cvt_pk_bf16_f32 v20, v72, v73
    v_cvt_pk_bf16_f32 v21, v74, v75
    v_cvt_pk_bf16_f32 v22, v76, v77
    v_cvt_pk_bf16_f32 v23, v78, v79
    v_pk_fma_f32 v[80:81], v[72:73], v[10:11], v[64:65] op_sel_hi:[1,0,1] neg_lo:[0,0,1] neg_hi:[0,0,1]
    v_pk_fma_f32 v[82:83], v[74:75], v[10:11], v[66:67] op_sel_hi:[1,0,1] neg_lo:[0,0,1] neg_hi:[0,0,1]
    v_pk_fma_f32 v[84:85], v[76:77], v[10:11], v[68:69] op_sel_hi:[1,0,1] neg_lo:[0,0,1] neg_hi:[0,0,1]
    v_pk_fma_f32 v[86:87], v[78:79], v[10:11], v[70:71] op_sel_hi:[1,0,1] neg_lo:[0,0,1] neg_hi:[0,0,1]
    v_cvt_pk_bf16_f32 v24, v80, v81
    v_cvt_pk_bf16_f32 v25, v82, v83
    v_cvt_pk_bf16_f32 v26, v84, v85
    v_cvt_pk_bf16_f32 v27, v86, v87
    v_pk_fma_f32 v[64:65], v[80:81], v[10:11], v[72:73] op_sel_hi:[1,0,1] neg_lo:[0,0,1] neg_hi:[0,0,1]
    v_pk_fma_f32 v[66:67], v[82:83], v[10:11], v[74:75] op_sel_hi:[1,0,1] neg_lo:[0,0,1] neg_hi:[0,0,1]
    v_pk_fma_f32 v[68:69], v[84:85], v[10:11], v[76:77] op_sel_hi:[1,0,1] neg_lo:[0,0,1] neg_hi:[0,0,1]
    v_pk_fma_f32 v[70:71], v[86:87], v[10:11], v[78:79] op_sel_hi:[1,0,1] neg_lo:[0,0,1] neg_hi:[0,0,1]
    v_cvt_pk_bf16_f32 v28, v64, v65
    v_cvt_pk_bf16_f32 v29, v66, v67
    v_cvt_pk_bf16_f32 v30, v68, v69
    v_cvt_pk_bf16_f32 v31, v70, v71
    v_pk_fma_f32 v[72:73], v[64:65], v[10:11], v[80:81] op_sel_hi:[1,0,1] neg_lo:[0,0,1] neg_hi:[0,0,1]
    v_pk_fma_f32 v[74:75], v[66:67], v[10:11], v[82:83] op_sel_hi:[1,0,1] neg_lo:[0,0,1] neg_hi:[0,0,1]
    v_pk_fma_f32 v[76:77], v[68:69], v[10:11], v[84:85] op_sel_hi:[1,0,1] neg_lo:[0,0,1] neg_hi:[0,0,1]
    v_pk_fma_f32 v[78:79], v[70:71], v[10:11], v[86:87] op_sel_hi:[1,0,1] neg_lo:[0,0,1] neg_hi:[0,0,1]
    v_cvt_pk_bf16_f32 v32, v72, v73
    v_cvt_pk_bf16_f32 v33, v74, v75
    v_cvt_pk_bf16_f32 v34, v76, v77
    v_cvt_pk_bf16_f32 v35, v78, v79
    v_pk_fma_f32 v[80:81], v[72:73], v[10:11], v[64:65] op_sel_hi:[1,0,1] neg_lo:[0,0,1] neg_hi:[0,0,1]
    v_pk_fma_f32 v[82:83], v[74:75], v[10:11], v[66:67] op_sel_hi:[1,0,1] neg_lo:[0,0,1] neg_hi:[0,0,1]
    v_pk_fma_f32 v[84:85], v[76:77], v[10:11], v[68:69] op_sel_hi:[1,0,1] neg_lo:[0,0,1] neg_hi:[0,0,1]
    v_pk_fma_f32 v[86:87], v[78:79], v[10:11], v[70:71] op_sel_hi:[1,0,1] neg_lo:[0,0,1] neg_hi:[0,0,1]
    v_cvt_pk_bf16_f32 v36, v80, v81
    v_cvt_pk_bf16_f32 v37, v82, v83
    v_cvt_pk_bf16_f32 v38, v84, v85
    v_cvt_pk_bf16_f32 v39, v86, v87
    v_pk_fma_f32 v[64:65], v[80:81], v[10:11], v[72:73] op_sel_hi:[1,0,1] neg_lo:[0,0,1] neg_hi:[0,0,1]
    v_pk_fma_f32 v[66:67], v[82:83], v[10:11], v[74:75] op_sel_hi:[1,0,1] neg_lo:[0,0,1] neg_hi:[0,0,1]
    v_pk_fma_f32 v[68:69], v[84:85], v[10:11], v[76:77] op_sel_hi:[1,0,1] neg_lo:[0,0,1] neg_hi:[0,0,1]
    v_pk_fma_f32 v[70:71], v[86:87], v[10:11], v[78:79] op_sel_hi:[1,0,1] neg_lo:[0,0,1] neg_hi:[0,0,1]
    v_cvt_pk_bf16_f32 v40, v64, v65
    v_cvt_pk_bf16_f32 v41, v66, v67
    v_cvt_pk_bf16_f32 v42, v68, v69
    v_cvt_pk_bf16_f32 v43, v70, v71
    v_pk_fma_f32 v[72:73], v[64:65], v[10:11], v[80:81] op_sel_hi:[1,0,1] neg_lo:[0,0,1] neg_hi:[0,0,1]
    v_pk_fma_f32 v[74:75], v[66:67], v[10:11], v[82:83] op_sel_hi:[1,0,1] neg_lo:[0,0,1] neg_hi:[0,0,1]
    v_pk_fma_f32 v[76:77], v[68:69], v[10:11], v[84:85] op_sel_hi:[1,0,1] neg_lo:[0,0,1] neg_hi:[0,0,1]
    v_pk_fma_f32 v[78:79], v[70:71], v[10:11], v[86:87] op_sel_hi:[1,0,1] neg_lo:[0,0,1] neg_hi:[0,0,1]
    v_cvt_pk_bf16_f32 v44, v72, v73
    v_cvt_pk_bf16_f32 v45, v74, v75
    v_cvt_pk_bf16_f32 v46, v76, v77
    v_cvt_pk_bf16_f32 v47, v78, v79
    v_bfe_u32 v10, v1, 2, 2
    v_lshl_add_u32 v10, v4, 3, v10
    v_lshlrev_b32 v10, 7, v10
    v_bfe_u32 v11, v1, 4, 1
    v_lshl_add_u32 v10, v11, 5, v10
    v_and_b32 v11, 1, v1
    v_lshl_add_u32 v10, v11, 4, v10
    v_bfe_u32 v11, v1, 1, 1
    v_lshl_add_u32 v10, v11, 3, v10
    v_bfe_u32 v11, v1, 3, 1
    v_lshl_add_u32 v10, v11, 6, v10
    v_xor_b32 v11, 64, v10
    s_lshl_b32 s32, s26, 12
    s_add_u32 s32, s32, 74240
    v_add_u32 v10, s32, v10
    v_add_u32 v11, s32, v11
    v_lshlrev_b32 v12, 5, v4
    v_add_u32 v12, 147968, v12
    v_mov_b32 v14, 0
    v_mov_b32 v15, 0xbf803f80
    v_cmp_eq_u32 s[42:43], 0, v7
    s_cmp_eq_u32 s27, 1
    s_cselect_b64 s[44:45], s[42:43], 0
    v_lshlrev_b32 v5, 4, v4
    v_add_u32 v5, 160768, v5
    s_or_b32 s33, s22, s27
    v_mov_b32 v160, 0
    v_mov_b32 v161, 0
    v_mov_b32 v162, 0
    v_mov_b32 v163, 0
    v_subrev_u32 v9, 1024, v5
    v_cndmask_b32 v5, v5, v9, s[42:43]
    s_mov_b64 s[62:63], 0
    s_mov_b32 s59, 0
km_q0dryback:
    s_lshl_b32 s32, s27, 12
    s_add_u32 s32, s32, 139776
    v_add_u32 v8, s32, v3
    s_waitcnt lgkmcnt(0)
    s_and_b32 s37, s26, 1
    s_lshr_b32 s38, s26, 1
    s_barrier
    ds_read_b128 v[48:51], v8 offset:0
    ds_read_b128 v[52:55], v8 offset:1024
    ds_read_b128 v[56:59], v8 offset:2048
    ds_read_b128 v[60:63], v8 offset:3072
    ds_read_b64_tr_b16 v[112:113], v10 offset:0
    ds_read_b64_tr_b16 v[114:115], v10 offset:512
    ds_read_b64_tr_b16 v[116:117], v10 offset:2048
    ds_read_b64_tr_b16 v[118:119], v10 offset:2560
    ds_read_b64_tr_b16 v[120:121], v11 offset:0
    ds_read_b64_tr_b16 v[122:123], v11 offset:512
    ds_read_b64_tr_b16 v[124:125], v11 offset:2048
    ds_read_b64_tr_b16 v[126:127], v11 offset:2560
    ds_read_b64_tr_b16 v[128:129], v10 offset:16384
    ds_read_b64_tr_b16 v[130:131], v10 offset:16896
    ds_read_b64_tr_b16 v[132:133], v10 offset:18432
    ds_read_b64_tr_b16 v[134:135], v10 offset:18944
    ds_read_b64_tr_b16 v[136:137], v11 offset:16384
    ds_read_b64_tr_b16 v[138:139], v11 offset:16896
    ds_read_b64_tr_b16 v[140:141], v11 offset:18432
    ds_read_b64_tr_b16 v[142:143], v11 offset:18944
    s_add_u32 s32, s25, 0
    s_and_b32 s32, s32, 15
    s_lshl_b32 s32, s32, 7
    v_add_u32 v13, s32, v12
    ds_read_b128 v[144:147], v13 offset:0
    ds_read_b128 v[148:151], v13 offset:16
    ds_read_b128 v[152:155], v13 offset:64
    ds_read_b128 v[156:159], v13 offset:80
    s_waitcnt lgkmcnt(15)
    v_mfma_f32_32x32x16_bf16 v[64:79], v[112:115], v[48:51], 0
    s_waitcnt lgkmcnt(15)
    v_mfma_f32_32x32x16_bf16 v[64:79], v[116:119], v[52:55], v[64:79]
    s_waitcnt lgkmcnt(14)
    v_mfma_f32_32x32x16_bf16 v[64:79], v[120:123], v[56:59], v[64:79]
    s_waitcnt lgkmcnt(12)
    v_mfma_f32_32x32x16_bf16 v[64:79], v[124:127], v[60:63], v[64:79]
    s_waitcnt lgkmcnt(10)
    v_mfma_f32_32x32x16_bf16 v[80:95], v[128:131], v[48:51], 0
    s_waitcnt lgkmcnt(0)
    s_nop 7
    s_nop 0
    v_mul_f32 v64, v64, v144
    v_mul_f32 v65, v65, v145
    v_mul_f32 v66, v66, v146
    v_mul_f32 v67, v67, v147
    v_mul_f32 v68, v68, v148
    v_mul_f32 v69, v69, v149
    s_waitcnt lgkmcnt(8)
    v_mfma_f32_32x32x16_bf16 v[80:95], v[132:135], v[52:55], v[80:95]
    v_mul_f32 v70, v70, v150
    v_mul_f32 v71, v71, v151
    v_mul_f32 v72, v72, v152
    v_mul_f32 v73, v73, v153
    v_mul_f32 v74, v74, v154
    v_mul_f32 v75, v75, v155
    s_waitcnt lgkmcnt(6)
    v_mfma_f32_32x32x16_bf16 v[80:95], v[136:139], v[56:59], v[80:95]
    v_mul_f32 v76, v76, v156
    v_mul_f32 v77, v77, v157
    v_mul_f32 v78, v78, v158
    v_mul_f32 v79, v79, v159
    s_add_u32 s32, s25, 1
    s_and_b32 s32, s32, 15
    s_lshl_b32 s32, s32, 7
    v_add_u32 v13, s32, v12
    ds_read_b128 v[144:147], v13 offset:0
    ds_read_b128 v[148:151], v13 offset:16
    ds_read_b128 v[152:155], v13 offset:64
    ds_read_b128 v[156:159], v13 offset:80
    v_cvt_pk_bf16_f32 v64, v64, v65
    s_waitcnt lgkmcnt(8)
    v_mfma_f32_32x32x16_bf16 v[80:95], v[140:143], v[60:63], v[80:95]
    s_barrier
    ds_read_b64_tr_b16 v[112:113], v10 offset:32768
    ds_read_b64_tr_b16 v[114:115], v10 offset:33280
    ds_read_b64_tr_b16 v[116:117], v10 offset:34816
    ds_read_b64_tr_b16 v[118:119], v10 offset:35328
    ds_read_b64_tr_b16 v[120:121], v11 offset:32768
    ds_read_b64_tr_b16 v[122:123], v11 offset:33280
    ds_read_b64_tr_b16 v[124:125], v11 offset:34816
    ds_read_b64_tr_b16 v[126:127], v11 offset:35328
    v_cvt_pk_bf16_f32 v65, v66, v67
    v_cvt_pk_bf16_f32 v66, v68, v69
    v_cvt_pk_bf16_f32 v67, v70, v71
    v_cvt_pk_bf16_f32 v68, v72, v73
    v_cvt_pk_bf16_f32 v69, v74, v75
    v_cvt_pk_bf16_f32 v70, v76, v77
    v_cvt_pk_bf16_f32 v71, v78, v79
    s_cmp_lg_u32 s33, 0
    v_mfma_f32_32x32x16_bf16 v[96:111], v[16:19], v[64:67], 0
    v_mfma_f32_32x32x16_bf16 v[96:111], v[20:23], v[68:71], v[96:111]
    s_cbranch_scc1 km_nd0
    v_dot2c_f32_bf16 v160, v64, v15
    v_dot2c_f32_bf16 v161, v65, v15
    v_dot2c_f32_bf16 v162, v66, v15
    v_dot2c_f32_bf16 v163, v67, v15
    v_dot2c_f32_bf16 v160, v68, v15
    v_dot2c_f32_bf16 v161, v69, v15
    v_dot2c_f32_bf16 v162, v70, v15
    v_dot2c_f32_bf16 v163, v71, v15
km_nd0:
    s_waitcnt lgkmcnt(6)
    v_mfma_f32_32x32x16_bf16 v[64:79], v[112:115], v[48:51], 0
    ds_read_b64_tr_b16 v[128:129], v10 offset:49152
    ds_read_b64_tr_b16 v[130:131], v10 offset:49664
    ds_read_b64_tr_b16 v[132:133], v10 offset:51200
    ds_read_b64_tr_b16 v[134:135], v10 offset:51712
    ds_read_b64_tr_b16 v[136:137], v11 offset:49152
    ds_read_b64_tr_b16 v[138:139], v11 offset:49664
    ds_read_b64_tr_b16 v[140:141], v11 offset:51200
    ds_read_b64_tr_b16 v[142:143], v11 offset:51712
    s_waitcnt lgkmcnt(15)
    v_mul_f32 v80, v80, v144
    v_mul_f32 v81, v81, v145
    v_mul_f32 v82, v82, v146
    v_mul_f32 v83, v83, v147
    v_mul_f32 v84, v84, v148
    v_mul_f32 v85, v85, v149
    s_waitcnt lgkmcnt(12)
    v_mfma_f32_32x32x16_bf16 v[64:79], v[116:119], v[52:55], v[64:79]
    v_mul_f32 v86, v86, v150
    v_mul_f32 v87, v87, v151
    v_mul_f32 v88, v88, v152
    v_mul_f32 v89, v89, v153
    v_mul_f32 v90, v90, v154
    v_mul_f32 v91, v91, v155
    s_waitcnt lgkmcnt(10)
    v_mfma_f32_32x32x16_bf16 v[64:79], v[120:123], v[56:59], v[64:79]
    v_mul_f32 v92, v92, v156
    v_mul_f32 v93, v93, v157
    v_mul_f32 v94, v94, v158
    v_mul_f32 v95, v95, v159
    s_add_u32 s32, s25, 2
    s_and_b32 s32, s32, 15
    s_lshl_b32 s32, s32, 7
    v_add_u32 v13, s32, v12
    ds_read_b128 v[144:147], v13 offset:0
    ds_read_b128 v[148:151], v13 offset:16
    ds_read_b128 v[152:155], v13 offset:64
    ds_read_b128 v[156:159], v13 offset:80
    v_cvt_pk_bf16_f32 v80, v80, v81
    s_waitcnt lgkmcnt(12)
    v_mfma_f32_32x32x16_bf16 v[64:79], v[124:127], v[60:63], v[64:79]
    v_cvt_pk_bf16_f32 v81, v82, v83
    v_cvt_pk_bf16_f32 v82, v84, v85
    v_cvt_pk_bf16_f32 v83, v86, v87
    v_cvt_pk_bf16_f32 v84, v88, v89
    v_cvt_pk_bf16_f32 v85, v90, v91
    v_cvt_pk_bf16_f32 v86, v92, v93
    v_cvt_pk_bf16_f32 v87, v94, v95
    s_cmp_lg_u32 s33, 0
    v_mfma_f32_32x32x16_bf16 v[96:111], v[24:27], v[80:83], v[96:111]
    v_mfma_f32_32x32x16_bf16 v[96:111], v[28:31], v[84:87], v[96:111]
    s_cbranch_scc1 km_nd1
    v_dot2c_f32_bf16 v160, v80, v15
    v_dot2c_f32_bf16 v161, v81, v15
    v_dot2c_f32_bf16 v162, v82, v15
    v_dot2c_f32_bf16 v163, v83, v15
    v_dot2c_f32_bf16 v160, v84, v15
    v_dot2c_f32_bf16 v161, v85, v15
    v_dot2c_f32_bf16 v162, v86, v15
    v_dot2c_f32_bf16 v163, v87, v15
km_nd1:
    s_waitcnt lgkmcnt(10)
    v_mfma_f32_32x32x16_bf16 v[80:95], v[128:131], v[48:51], 0
    s_waitcnt lgkmcnt(0)
    v_mul_f32 v64, v64, v144
    v_mul_f32 v65, v65, v145
    v_mul_f32 v66, v66, v146
    v_mul_f32 v67, v67, v147
    v_mul_f32 v68, v68, v148
    v_mul_f32 v69, v69, v149
    s_waitcnt lgkmcnt(8)
    v_mfma_f32_32x32x16_bf16 v[80:95], v[132:135], v[52:55], v[80:95]
    v_mul_f32 v70, v70, v150
    v_mul_f32 v71, v71, v151
    v_mul_f32 v72, v72, v152
    v_mul_f32 v73, v73, v153
    v_mul_f32 v74, v74, v154
    v_mul_f32 v75, v75, v155
    s_waitcnt lgkmcnt(6)
    v_mfma_f32_32x32x16_bf16 v[80:95], v[136:139], v[56:59], v[80:95]
    v_mul_f32 v76, v76, v156
    v_mul_f32 v77, v77, v157
    v_mul_f32 v78, v78, v158
    v_mul_f32 v79, v79, v159
    s_add_u32 s32, s25, 3
    s_and_b32 s32, s32, 15
    s_lshl_b32 s32, s32, 7
    v_add_u32 v13, s32, v12
    ds_read_b128 v[144:147], v13 offset:0
    ds_read_b128 v[148:151], v13 offset:16
    ds_read_b128 v[152:155], v13 offset:64
    ds_read_b128 v[156:159], v13 offset:80
    v_cvt_pk_bf16_f32 v64, v64, v65
    s_waitcnt lgkmcnt(8)
    v_mfma_f32_32x32x16_bf16 v[80:95], v[140:143], v[60:63], v[80:95]
    v_cvt_pk_bf16_f32 v65, v66, v67
    v_cvt_pk_bf16_f32 v66, v68, v69
    v_cvt_pk_bf16_f32 v67, v70, v71
    v_cvt_pk_bf16_f32 v68, v72, v73
    v_cvt_pk_bf16_f32 v69, v74, v75
    v_cvt_pk_bf16_f32 v70, v76, v77
    v_cvt_pk_bf16_f32 v71, v78, v79
    s_cmp_lg_u32 s33, 0
    v_mfma_f32_32x32x16_bf16 v[96:111], v[32:35], v[64:67], v[96:111]
    v_mfma_f32_32x32x16_bf16 v[96:111], v[36:39], v[68:71], v[96:111]
    s_cbranch_scc1 km_nd2
    v_dot2c_f32_bf16 v160, v64, v15
    v_dot2c_f32_bf16 v161, v65, v15
    v_dot2c_f32_bf16 v162, v66, v15
    v_dot2c_f32_bf16 v163, v67, v15
    v_dot2c_f32_bf16 v160, v68, v15
    v_dot2c_f32_bf16 v161, v69, v15
    v_dot2c_f32_bf16 v162, v70, v15
    v_dot2c_f32_bf16 v163, v71, v15
km_nd2:
    s_waitcnt lgkmcnt(0)
    v_mul_f32 v80, v80, v144
    v_mul_f32 v81, v81, v145
    v_mul_f32 v82, v82, v146
    v_mul_f32 v83, v83, v147
    v_mul_f32 v84, v84, v148
    v_mul_f32 v85, v85, v149
    v_mul_f32 v86, v86, v150
    v_mul_f32 v87, v87, v151
    v_mul_f32 v88, v88, v152
    v_mul_f32 v89, v89, v153
    v_mul_f32 v90, v90, v154
    v_mul_f32 v91, v91, v155
    v_mul_f32 v92, v92, v156
    v_mul_f32 v93, v93, v157
    v_mul_f32 v94, v94, v158
    v_mul_f32 v95, v95, v159
    v_cvt_pk_bf16_f32 v80, v80, v81
    v_cvt_pk_bf16_f32 v81, v82, v83
    v_cvt_pk_bf16_f32 v82, v84, v85
    v_cvt_pk_bf16_f32 v83, v86, v87
    v_cvt_pk_bf16_f32 v84, v88, v89
    v_cvt_pk_bf16_f32 v85, v90, v91
    v_cvt_pk_bf16_f32 v86, v92, v93
    v_cvt_pk_bf16_f32 v87, v94, v95
    s_cmp_lg_u32 s33, 0
    v_mfma_f32_32x32x16_bf16 v[96:111], v[40:43], v[80:83], v[96:111]
    v_mfma_f32_32x32x16_bf16 v[96:111], v[44:47], v[84:87], v[96:111]
    s_cbranch_scc1 km_nd3
    v_dot2c_f32_bf16 v160, v80, v15
    v_dot2c_f32_bf16 v161, v81, v15
    v_dot2c_f32_bf16 v162, v82, v15
    v_dot2c_f32_bf16 v163, v83, v15
    v_dot2c_f32_bf16 v160, v84, v15
    v_dot2c_f32_bf16 v161, v85, v15
    v_dot2c_f32_bf16 v162, v86, v15
    v_dot2c_f32_bf16 v163, v87, v15
    s_nop 2
    v_add_f32 v160, v160, v161
    v_add_f32 v162, v162, v163
    v_add_f32 v14, v160, v162
km_nd3:
    s_lshl_b32 s32, s3, 12
    s_add_u32 s32, s32, 74240
    v_add_u32 v11, s32, v3
    s_lshl_b32 s32, s26, 8
    s_add_u32 s32, s32, 154112
    v_lshl_add_u32 v12, v1, 2, s32
    s_cmp_eq_u32 s27, 0
    s_cselect_b64 s[30:31], -1, 0
    s_andn2_b64 s[34:35], s[30:31], s[42:43]
    s_cmp_eq_u32 s23, 0
    s_cbranch_scc1 km_q0tail
km_q0back:
    s_nop 3
    s_andn2_b64 exec, -1, s[44:45]
    ds_write_b128 v11, v[96:99] offset:0
    ds_write_b128 v11, v[100:103] offset:1024
    ds_write_b128 v11, v[104:107] offset:2048
    ds_write_b128 v11, v[108:111] offset:3072
    s_mov_b64 exec, s[30:31]
    ds_write_b32 v12, v14
    s_mov_b64 exec, s[34:35]
    ds_write_b32 v12, v14 offset:1024
    s_mov_b64 exec, -1
    s_waitcnt lgkmcnt(0)
    v_mov_b32 v8, 163332
    v_mov_b32 v9, 1
    s_mov_b64 exec, 1
    ds_add_u32 v8, v9
    s_mov_b64 exec, -1
    s_mov_b32 s46, 0xffff0000
    s_and_b32 s49, s21, 3
    s_lshr_b32 s48, s21, 2
    s_lshl_b32 s50, s49, 1
    s_add_u32 s50, s50, s48
    s_lshl_b32 s50, s50, 1
    s_and_b32 s50, s50, 15
    s_and_b32 s51, s20, 4
    s_add_u32 s49, s49, s51
    s_min_u32 s51, s49, 6
    s_cmp_ge_u32 s21, 28
    s_cselect_b32 s48, s51, s48
    s_and_b32 s51, s20, 3
    s_mul_i32 s51, s51, 7
    s_add_u32 s48, s48, s51
    s_cmp_eq_u32 s27, 0
    s_cbranch_scc1 km_C
    s_lshl_b32 s30, s37, 1
    v_add_u32 v9, s30, v4
    s_lshl_b32 s39, s22, 7
    v_lshl_add_u32 v7, v9, 5, s39
    s_lshl_b32 s30, s38, 12
    s_add_u32 s30, s30, 139776
    v_lshl_add_u32 v13, v6, 6, s30
    v_lshl_add_u32 v14, v9, 4, v13
    v_lshlrev_b32 v15, 4, v9
    v_sub_u32 v15, v13, v15
    s_lshl_b32 s30, s38, 8
    s_add_u32 s30, s30, 154048
    v_lshl_add_u32 v13, v6, 2, s30
    v_cmp_eq_u32 vcc, 0, v9
    s_nop 1
    v_cndmask_b32 v13, v15, v13, vcc
    v_add_u32 v21, 150016, v7
    s_lshl_b32 s32, s37, 11
    s_add_u32 s32, s32, 74240
    v_add_u32 v11, s32, v3
    s_cmp_eq_u32 s38, 0
    s_cselect_b32 s34, -1.0, 1.0
    s_cselect_b32 s35, 0, 1.0
    v_mov_b32 v16, s34
    v_mov_b32 v17, s35
    v_sub_f32 v18, 0, v16
    v_sub_f32 v22, 1.0, v17
    v_cndmask_b32 v16, v16, v17, s[42:43]
    v_cndmask_b32 v18, v18, v17, s[42:43]
    v_cndmask_b32 v22, 1.0, v22, s[42:43]
    s_lshl_b32 s39, s38, 5
    s_add_u32 s39, s39, s23
    s_lshl_b32 s36, s39, 15
    s_lshl_b32 s33, s22, 1
    s_add_u32 s33, s33, s37
    s_lshl_b32 s33, s33, 10
    s_add_u32 s36, s36, s33
    s_lshl_b32 s32, s38, 10
    s_add_u32 s32, s32, 154112
    v_lshl_add_u32 v20, v1, 2, s32
    s_or_b32 s33, s22, s37
    s_cmp_eq_u32 s33, 0
    s_cselect_b32 s30, -1, 0
    s_mov_b32 s31, 0
    s_setprio 0
    v_mov_b32 v8, 163332
    s_mov_b32 s57, 0
km_spinR:
    ds_read_b32 v9, v8
    s_waitcnt lgkmcnt(0)
    v_readfirstlane_b32 s56, v9
    s_nop 0
    s_cmp_ge_u32 s56, 10
    s_cbranch_scc1 km_spinR_ok
    s_sleep 1
    s_add_u32 s57, s57, 1
    s_cmp_lt_u32 s57, 2097152
    s_cbranch_scc1 km_spinR
km_spinR_ok:
    s_setprio 3
    ds_read_b128 v[156:159], v14
    ds_read_b128 v[160:163], v15 offset:2096
    ds_read_u16 v2, v13 offset:2112
    ds_read_b128 v[56:59], v11 offset:0
    ds_read_b128 v[60:63], v11 offset:1024
    ds_read_b128 v[64:67], v11 offset:4096
    ds_read_b128 v[68:71], v11 offset:5120
    ds_read_b128 v[72:75], v11 offset:8192
    ds_read_b128 v[76:79], v11 offset:9216
    ds_read_b128 v[80:83], v11 offset:12288
    ds_read_b128 v[84:87], v11 offset:13312
    ds_read_b128 v[88:91], v11 offset:16384
    ds_read_b128 v[92:95], v11 offset:17408
    ds_read_b128 v[96:99], v11 offset:20480
    ds_read_b128 v[100:103], v11 offset:21504
    ds_read_b128 v[104:107], v11 offset:24576
    ds_read_b128 v[108:111], v11 offset:25600
    ds_read_b128 v[112:115], v11 offset:28672
    ds_read_b128 v[116:119], v11 offset:29696
    s_waitcnt lgkmcnt(15)
    v_lshlrev_b32 v120, 16, v156
    v_and_b32 v121, s46, v156
    v_lshlrev_b32 v122, 16, v157
    v_and_b32 v123, s46, v157
    v_lshlrev_b32 v124, 16, v158
    v_and_b32 v125, s46, v158
    v_lshlrev_b32 v126, 16, v159
    v_and_b32 v127, s46, v159
    v_lshlrev_b32 v128, 16, v2
    v_and_b32 v129, s46, v163
    v_lshlrev_b32 v130, 16, v163
    v_and_b32 v131, s46, v162
    v_lshlrev_b32 v132, 16, v162
    v_and_b32 v133, s46, v161
    v_lshlrev_b32 v134, 16, v161
    v_and_b32 v135, s46, v160
    s_waitcnt lgkmcnt(8)
    ds_read_b128 v[24:27], v21 offset:0
    ds_read_b128 v[28:31], v21 offset:16
    ds_read_b128 v[40:43], v21 offset:1024
    ds_read_b128 v[44:47], v21 offset:1040
    ds_read_b128 v[32:35], v21 offset:2048
    ds_read_b128 v[36:39], v21 offset:2064
    ds_read_b128 v[48:51], v21 offset:3072
    ds_read_b128 v[52:55], v21 offset:3088
    ds_read2st64_b32 v[136:137], v20 offset0:0 offset1:1
    ds_read2st64_b32 v[138:139], v20 offset0:2 offset1:3
    v_pk_add_f32 v[56:57], v[56:57], v[64:65]
    v_pk_add_f32 v[72:73], v[72:73], v[80:81]
    v_pk_add_f32 v[58:59], v[58:59], v[66:67]
    v_pk_add_f32 v[74:75], v[74:75], v[82:83]
    v_pk_add_f32 v[60:61], v[60:61], v[68:69]
    v_pk_add_f32 v[76:77], v[76:77], v[84:85]
    v_pk_add_f32 v[62:63], v[62:63], v[70:71]
    v_pk_add_f32 v[78:79], v[78:79], v[86:87]
    v_pk_add_f32 v[56:57], v[56:57], v[72:73]
    v_pk_add_f32 v[58:59], v[58:59], v[74:75]
    v_pk_add_f32 v[60:61], v[60:61], v[76:77]
    v_pk_add_f32 v[62:63], v[62:63], v[78:79]
    s_waitcnt lgkmcnt(10)
    v_pk_add_f32 v[88:89], v[88:89], v[96:97]
    v_pk_add_f32 v[104:105], v[104:105], v[112:113]
    v_pk_add_f32 v[90:91], v[90:91], v[98:99]
    v_pk_add_f32 v[106:107], v[106:107], v[114:115]
    v_pk_add_f32 v[92:93], v[92:93], v[100:101]
    v_pk_add_f32 v[108:109], v[108:109], v[116:117]
    v_pk_add_f32 v[94:95], v[94:95], v[102:103]
    v_pk_add_f32 v[110:111], v[110:111], v[118:119]
    v_pk_add_f32 v[88:89], v[88:89], v[104:105]
    v_pk_add_f32 v[90:91], v[90:91], v[106:107]
    v_pk_add_f32 v[92:93], v[92:93], v[108:109]
    v_pk_add_f32 v[94:95], v[94:95], v[110:111]
    v_pk_mul_f32 v[56:57], v[56:57], v[22:23] op_sel_hi:[1,0]
    v_pk_mul_f32 v[58:59], v[58:59], v[22:23] op_sel_hi:[1,0]
    v_pk_mul_f32 v[60:61], v[60:61], v[22:23] op_sel_hi:[1,0]
    v_pk_mul_f32 v[62:63], v[62:63], v[22:23] op_sel_hi:[1,0]
    v_pk_fma_f32 v[64:65], v[88:89], v[16:17], v[56:57] op_sel_hi:[1,0,1]
    v_pk_fma_f32 v[72:73], v[88:89], v[18:19], v[56:57] op_sel_hi:[1,0,1]
    v_pk_fma_f32 v[66:67], v[90:91], v[16:17], v[58:59] op_sel_hi:[1,0,1]
    v_pk_fma_f32 v[74:75], v[90:91], v[18:19], v[58:59] op_sel_hi:[1,0,1]
    v_pk_fma_f32 v[68:69], v[92:93], v[16:17], v[60:61] op_sel_hi:[1,0,1]
    v_pk_fma_f32 v[76:77], v[92:93], v[18:19], v[60:61] op_sel_hi:[1,0,1]
    v_pk_fma_f32 v[70:71], v[94:95], v[16:17], v[62:63] op_sel_hi:[1,0,1]
    v_pk_fma_f32 v[78:79], v[94:95], v[18:19], v[62:63] op_sel_hi:[1,0,1]
    s_waitcnt lgkmcnt(0)
    v_pk_add_f32 v[136:137], v[136:137], v[138:139]
    v_add_f32 v136, v136, v137
    v_mov_b32 v137, v136
    s_nop 1
    v_permlane32_swap_b32 v137, v136
    v_add_f32 v136, v136, v137
    v_cndmask_b32 v72, v72, v136, s[30:31]
    v_pk_fma_f32 v[64:65], v[64:65], v[24:25], v[120:121]
    v_pk_fma_f32 v[66:67], v[66:67], v[26:27], v[122:123]
    v_pk_fma_f32 v[68:69], v[68:69], v[28:29], v[124:125]
    v_pk_fma_f32 v[70:71], v[70:71], v[30:31], v[126:127]
    v_pk_fma_f32 v[72:73], v[72:73], v[40:41], v[128:129]
    v_pk_fma_f32 v[74:75], v[74:75], v[42:43], v[130:131]
    v_pk_fma_f32 v[76:77], v[76:77], v[44:45], v[132:133]
    v_pk_fma_f32 v[78:79], v[78:79], v[46:47], v[134:135]
    v_pk_mul_f32 v[32:33], v[64:65], v[32:33]
    v_pk_mul_f32 v[34:35], v[66:67], v[34:35]
    v_pk_mul_f32 v[36:37], v[68:69], v[36:37]
    v_pk_mul_f32 v[38:39], v[70:71], v[38:39]
    v_pk_mul_f32 v[48:49], v[72:73], v[48:49]
    v_pk_mul_f32 v[50:51], v[74:75], v[50:51]
    v_pk_mul_f32 v[52:53], v[76:77], v[52:53]
    v_pk_mul_f32 v[54:55], v[78:79], v[54:55]
    s_add_u32 s32, s36, 0x500000
    s_add_u32 s33, s32, 16384
    s_add_u32 s34, s36, 0x300000
    s_add_u32 s35, s34, 16384
    v_cvt_pk_bf16_f32 v80, v32, v33
    v_cvt_pk_bf16_f32 v81, v34, v35
    v_cvt_pk_bf16_f32 v82, v36, v37
    v_cvt_pk_bf16_f32 v83, v38, v39
    buffer_store_dwordx4 v[80:83], v3, s[16:19], s32 offen sc1
    v_cvt_pk_bf16_f32 v84, v48, v49
    v_cvt_pk_bf16_f32 v85, v50, v51
    v_cvt_pk_bf16_f32 v86, v52, v53
    v_cvt_pk_bf16_f32 v87, v54, v55
    buffer_store_dwordx4 v[84:87], v3, s[16:19], s33 offen sc1
    v_cvt_pk_bf16_f32 v88, v64, v65
    v_cvt_pk_bf16_f32 v89, v66, v67
    v_cvt_pk_bf16_f32 v90, v68, v69
    v_cvt_pk_bf16_f32 v91, v70, v71
    buffer_store_dwordx4 v[88:91], v3, s[16:19], s34 offen sc1
    v_cvt_pk_bf16_f32 v92, v72, v73
    v_cvt_pk_bf16_f32 v93, v74, v75
    v_cvt_pk_bf16_f32 v94, v76, v77
    v_cvt_pk_bf16_f32 v95, v78, v79
    buffer_store_dwordx4 v[92:95], v3, s[16:19], s35 offen sc1
    v_pk_add_f32 v[96:97], v[64:65], v[66:67]
    v_pk_mul_f32 v[98:99], v[64:65], v[64:65]
    v_pk_fma_f32 v[98:99], v[66:67], v[66:67], v[98:99]
    v_pk_add_f32 v[96:97], v[96:97], v[68:69]
    v_pk_fma_f32 v[98:99], v[68:69], v[68:69], v[98:99]
    v_pk_add_f32 v[96:97], v[96:97], v[70:71]
    v_pk_fma_f32 v[98:99], v[70:71], v[70:71], v[98:99]
    v_pk_add_f32 v[96:97], v[96:97], v[72:73]
    v_pk_fma_f32 v[98:99], v[72:73], v[72:73], v[98:99]
    v_pk_add_f32 v[96:97], v[96:97], v[74:75]
    v_pk_fma_f32 v[98:99], v[74:75], v[74:75], v[98:99]
    v_pk_add_f32 v[96:97], v[96:97], v[76:77]
    v_pk_fma_f32 v[98:99], v[76:77], v[76:77], v[98:99]
    v_pk_add_f32 v[96:97], v[96:97], v[78:79]
    v_pk_fma_f32 v[98:99], v[78:79], v[78:79], v[98:99]
    v_add_f32 v100, v96, v97
    v_add_f32 v101, v98, v99
    v_mov_b32 v102, v100
    v_mov_b32 v103, v101
    s_nop 0
    v_permlane32_swap_b32 v102, v100
    v_permlane32_swap_b32 v103, v101
    v_add_f32 v100, v100, v102
    v_add_f32 v101, v101, v103
    s_lshl_b32 s32, s39, 12
    s_lshl_b32 s33, s22, 9
    s_add_u32 s32, s32, s33
    s_lshl_b32 s33, s37, 8
    s_add_u32 s32, s32, s33
    s_add_u32 s32, s32, 0x20000
    v_lshlrev_b32 v8, 3, v1
    s_mov_b32 exec_hi, 0
    buffer_store_dwordx2 v[100:101], v8, s[16:19], s32 offen sc1
    s_mov_b64 exec, -1
    s_lshl_b32 s32, s20, 8
    s_add_u32 s32, s32, 0x10000
    v_mov_b32 v8, 163364
    v_mov_b32 v9, 1
    s_mov_b64 exec, 1
    ds_add_u32 v8, v9
    s_mov_b64 exec, -1
    s_waitcnt vmcnt(0)
    v_mov_b32 v8, 163328
    v_mov_b32 v9, 1
    s_mov_b64 exec, 1
    ds_add_rtn_u32 v10, v8, v9
    s_waitcnt lgkmcnt(0)
    v_readfirstlane_b32 s56, v10
    s_nop 0
    s_cmp_lg_u32 s56, 3
    s_cbranch_scc1 km_arrB
    v_mov_b32 v8, 0
    s_mov_b32 s56, 1
    s_atomic_add s56, s[6:7], s32 glc
    s_waitcnt lgkmcnt(0)
    s_cmp_lg_u32 s56, 31
    s_cbranch_scc1 km_arrB
    buffer_store_dword v9, v8, s[16:19], s32 offen offset:128 sc1
km_arrB:
    s_mov_b64 exec, -1
    s_setprio 0
    s_branch km_C
km_q0tail:
    s_mov_b64 s[62:63], s[42:43]
    s_mov_b32 s59, 2
    s_setprio 3
km_q0dry:
    v_mov_b32 v8, 163360
    s_mov_b32 s57, 0
km_spinY:
    ds_read_b32 v9, v8 offset:0
    s_waitcnt lgkmcnt(0)
    v_readfirstlane_b32 s56, v9
    s_nop 0
    s_cmp_ge_u32 s56, s59
    s_cbranch_scc1 km_spinY_ok
    s_sleep 0
    s_add_u32 s57, s57, 1
    s_cmp_lt_u32 s57, 2097152
    s_cbranch_scc1 km_spinY
km_spinY_ok:
    s_cmp_lg_u32 s27, 0
    s_cbranch_scc1 km_q0ret
    s_add_u32 s32, s25, 0
    s_and_b32 s32, s32, 15
    s_lshl_b32 s32, s32, 6
    v_add_u32 v9, s32, v5
    ds_read_b128 v[128:131], v9 offset:0
    ds_read_b128 v[132:135], v9 offset:32
    s_add_u32 s32, s25, 1
    s_and_b32 s32, s32, 15
    s_lshl_b32 s32, s32, 6
    v_add_u32 v9, s32, v5
    ds_read_b128 v[136:139], v9 offset:0
    ds_read_b128 v[140:143], v9 offset:32
    s_add_u32 s32, s25, 2
    s_and_b32 s32, s32, 15
    s_lshl_b32 s32, s32, 6
    v_add_u32 v9, s32, v5
    ds_read_b128 v[144:147], v9 offset:0
    ds_read_b128 v[148:151], v9 offset:32
    s_add_u32 s32, s25, 3
    s_and_b32 s32, s32, 15
    s_lshl_b32 s32, s32, 6
    v_add_u32 v9, s32, v5
    ds_read_b128 v[152:155], v9 offset:0
    ds_read_b128 v[156:159], v9 offset:32
    v_mov_b32 v164, 0
    v_mov_b32 v165, 0
    v_mov_b32 v166, 0
    v_mov_b32 v167, 0
    s_waitcnt lgkmcnt(7)
    v_mfma_f32_32x32x16_bf16 v[112:127], v[16:19], v[128:131], 0
    v_dot2c_f32_bf16 v164, v128, v15
    v_dot2c_f32_bf16 v165, v129, v15
    v_dot2c_f32_bf16 v166, v130, v15
    v_dot2c_f32_bf16 v167, v131, v15
    s_waitcnt lgkmcnt(6)
    v_mfma_f32_32x32x16_bf16 v[112:127], v[20:23], v[132:135], v[112:127]
    v_dot2c_f32_bf16 v164, v132, v15
    v_dot2c_f32_bf16 v165, v133, v15
    v_dot2c_f32_bf16 v166, v134, v15
    v_dot2c_f32_bf16 v167, v135, v15
    s_waitcnt lgkmcnt(5)
    v_mfma_f32_32x32x16_bf16 v[112:127], v[24:27], v[136:139], v[112:127]
    v_dot2c_f32_bf16 v164, v136, v15
    v_dot2c_f32_bf16 v165, v137, v15
    v_dot2c_f32_bf16 v166, v138, v15
    v_dot2c_f32_bf16 v167, v139, v15
    s_waitcnt lgkmcnt(4)
    v_mfma_f32_32x32x16_bf16 v[112:127], v[28:31], v[140:143], v[112:127]
    v_dot2c_f32_bf16 v164, v140, v15
    v_dot2c_f32_bf16 v165, v141, v15
    v_dot2c_f32_bf16 v166, v142, v15
    v_dot2c_f32_bf16 v167, v143, v15
    s_waitcnt lgkmcnt(3)
    v_mfma_f32_32x32x16_bf16 v[112:127], v[32:35], v[144:147], v[112:127]
    v_dot2c_f32_bf16 v164, v144, v15
    v_dot2c_f32_bf16 v165, v145, v15
    v_dot2c_f32_bf16 v166, v146, v15
    v_dot2c_f32_bf16 v167, v147, v15
    s_waitcnt lgkmcnt(2)
    v_mfma_f32_32x32x16_bf16 v[112:127], v[36:39], v[148:151], v[112:127]
    v_dot2c_f32_bf16 v164, v148, v15
    v_dot2c_f32_bf16 v165, v149, v15
    v_dot2c_f32_bf16 v166, v150, v15
    v_dot2c_f32_bf16 v167, v151, v15
    s_waitcnt lgkmcnt(1)
    v_mfma_f32_32x32x16_bf16 v[112:127], v[40:43], v[152:155], v[112:127]
    v_dot2c_f32_bf16 v164, v152, v15
    v_dot2c_f32_bf16 v165, v153, v15
    v_dot2c_f32_bf16 v166, v154, v15
    v_dot2c_f32_bf16 v167, v155, v15
    s_waitcnt lgkmcnt(0)
    v_mfma_f32_32x32x16_bf16 v[112:127], v[44:47], v[156:159], v[112:127]
    v_dot2c_f32_bf16 v164, v156, v15
    v_dot2c_f32_bf16 v165, v157, v15
    v_dot2c_f32_bf16 v166, v158, v15
    v_dot2c_f32_bf16 v167, v159, v15
    s_nop 2
    v_add_f32 v164, v164, v165
    v_add_f32 v166, v166, v167
    v_add_f32 v13, v164, v166
    s_mov_b64 exec, s[62:63]
    v_add_f32 v14, v14, v13
    v_pk_add_f32 v[96:97], v[96:97], v[112:113]
    v_pk_add_f32 v[98:99], v[98:99], v[114:115]
    v_pk_add_f32 v[100:101], v[100:101], v[116:117]
    v_pk_add_f32 v[102:103], v[102:103], v[118:119]
    v_pk_add_f32 v[104:105], v[104:105], v[120:121]
    v_pk_add_f32 v[106:107], v[106:107], v[122:123]
    v_pk_add_f32 v[108:109], v[108:109], v[124:125]
    v_pk_add_f32 v[110:111], v[110:111], v[126:127]
    s_lshl_b64 exec, s[62:63], 1
    ds_write_b128 v11, v[112:115] offset:16368
    ds_write_b128 v11, v[116:119] offset:17392
    ds_write_b128 v11, v[120:123] offset:18416
    ds_write_b128 v11, v[124:127] offset:19440
    ds_write_b32 v12, v13 offset:1020
    s_mov_b64 exec, -1
km_q0ret:
    s_cmp_eq_u32 s59, 0
    s_cbranch_scc1 km_q0dryback
    s_branch km_q0back
km_C:
    s_setprio 0
    v_bfe_u32 v10, v1, 4, 1
    v_bfe_u32 v11, v1, 2, 2
    v_lshl_add_u32 v12, v4, 3, v11
    v_lshlrev_b32 v12, 7, v12
    v_lshl_add_u32 v12, v10, 12, v12
    v_and_b32 v11, 2, v11
    v_or_b32 v11, v11, v10
    v_lshl_add_u32 v12, v11, 5, v12
    v_and_b32 v11, 1, v1
    v_lshl_add_u32 v12, v11, 4, v12
    v_bfe_u32 v11, v1, 1, 1
    v_lshl_add_u32 v12, v11, 3, v12
    v_xor_b32 v13, 32, v12
    v_xor_b32 v14, 64, v12
    v_xor_b32 v15, 96, v12
    v_mov_b32 v0, 163376
    v_mov_b32 v2, 1
    s_lshl_b32 s34, s48, 7
    s_add_u32 s34, s34, 0x11800
    s_lshl_b32 s35, s48, 11
    s_add_u32 s35, s35, 0x80000
    v_lshlrev_b32 v7, 4, v6
    s_cmp_ge_u32 s21, 28
    s_cbranch_scc1 km_csb
    s_lshl_b32 s28, s49, 2
    s_add_u32 s28, s28, s26
    s_lshl_b32 s29, s27, 5
    s_add_u32 s28, s28, s29
    s_lshl_b32 s36, s28, 15
    s_add_u32 s36, s36, 0x500000
    s_lshl_b32 s37, s50, 11
    s_lshl_b32 s39, s28, 12
    s_add_u32 s39, s39, 0x20000
    v_lshlrev_b32 v5, 3, v6
    v_lshl_add_u32 v5, v4, 11, v5
    s_mov_b32 s44, 0xbdd2d3e8
    s_mul_i32 s40, s28, 114688
    s_lshl_b32 s41, s48, 12
    s_add_u32 s40, s40, s41
    s_add_u32 s40, s40, 0x700000
    s_lshr_b32 s41, s28, 2
    s_lshl_b32 s41, s41, 8
    s_add_u32 s41, s41, 0x10800
    s_lshl_b32 s42, s27, 2
    s_add_u32 s42, s42, 163336
    s_lshl_b32 s32, s49, 8
    s_add_u32 s32, s32, 0x10080
    s_cmp_lg_u32 s3, 0
    s_cbranch_scc1 km_c_w
    v_mov_b32 v8, 163328
    s_mov_b32 s57, 0
km_spinZ:
    ds_read_b32 v9, v8
    s_waitcnt lgkmcnt(0)
    v_readfirstlane_b32 s56, v9
    s_nop 0
    s_cmp_ge_u32 s56, 4
    s_cbranch_scc1 km_spinZ_ok
    s_sleep 1
    s_add_u32 s57, s57, 1
    s_cmp_lt_u32 s57, 2097152
    s_cbranch_scc1 km_spinZ
km_spinZ_ok:
    v_lshlrev_b32 v8, 2, v1
    s_mov_b32 s57, 0
    s_mov_b32 exec_lo, 0x1
    s_mov_b32 exec_hi, 0
km_pollB:
    buffer_load_dword v9, v8, s[16:19], s32 offen sc1
    s_waitcnt vmcnt(0)
    v_cmp_lt_u32 vcc, 0, v9
    s_nop 0
    s_cmp_eq_u32 vcc_lo, 0x1
    s_cbranch_scc1 km_pollB_ok
    s_sleep 2
    s_add_u32 s57, s57, 1
    s_cmp_lt_u32 s57, 131072
    s_cbranch_scc1 km_pollB
km_pollB_ok:
    s_mov_b64 exec, -1
    v_mov_b32 v8, 163352
    v_mov_b32 v9, 1
    s_mov_b64 exec, 1
    ds_add_u32 v8, v9
    s_mov_b64 exec, -1
    s_branch km_c_go
km_c_w:
    v_mov_b32 v8, 163352
    s_mov_b32 s57, 0
km_spinG:
    ds_read_b32 v9, v8
    s_waitcnt lgkmcnt(0)
    v_readfirstlane_b32 s56, v9
    s_nop 0
    s_cmp_ge_u32 s56, 1
    s_cbranch_scc1 km_spinG_ok
    s_sleep 1
    s_add_u32 s57, s57, 1
    s_cmp_lt_u32 s57, 2097152
    s_cbranch_scc1 km_spinG
km_spinG_ok:
km_c_go:
    s_cmp_eq_u32 s27, 0
    s_cbranch_scc1 km_c_pa
    s_setprio 1
    s_branch km_c_pb
km_c_pa:
    s_setprio 1
km_c_pb:
    s_add_u32 s38, s36, s37
    s_add_u32 s37, s37, 2048
    s_and_b32 s37, s37, 32767
    buffer_load_dwordx4 v[104:107], v3, s[16:19], s38 offen offset:0 sc1
    buffer_load_dwordx4 v[108:111], v3, s[16:19], s38 offen offset:1024 sc1
    s_add_u32 s38, s36, s37
    s_add_u32 s37, s37, 2048
    s_and_b32 s37, s37, 32767
    buffer_load_dwordx4 v[112:115], v3, s[16:19], s38 offen offset:0 sc1
    buffer_load_dwordx4 v[116:119], v3, s[16:19], s38 offen offset:1024 sc1
    v_mov_b32 v8, 163344
    s_mov_b32 s57, 0
km_spinW1:
    ds_read_b32 v9, v8
    s_waitcnt lgkmcnt(0)
    v_readfirstlane_b32 s56, v9
    s_nop 0
    s_cmp_ge_u32 s56, 2
    s_cbranch_scc1 km_spinW1_ok
    s_sleep 1
    s_add_u32 s57, s57, 1
    s_cmp_lt_u32 s57, 2097152
    s_cbranch_scc1 km_spinW1
km_spinW1_ok:
    ds_read_b64_tr_b16 v[80:81], v12 offset:0
    ds_read_b64_tr_b16 v[82:83], v12 offset:512
    ds_read_b64_tr_b16 v[84:85], v13 offset:0
    ds_read_b64_tr_b16 v[86:87], v13 offset:512
    ds_read_b64_tr_b16 v[88:89], v14 offset:0
    ds_read_b64_tr_b16 v[90:91], v14 offset:512
    ds_read_b64_tr_b16 v[92:93], v15 offset:0
    ds_read_b64_tr_b16 v[94:95], v15 offset:512
    ds_read_b64_tr_b16 v[96:97], v12 offset:2048
    ds_read_b64_tr_b16 v[98:99], v12 offset:2560
    s_waitcnt vmcnt(3)
    s_waitcnt lgkmcnt(8)
    v_mfma_f32_32x32x16_bf16 v[16:31], v[80:83], v[104:107], 0
    ds_read_b64_tr_b16 v[100:101], v13 offset:2048
    ds_read_b64_tr_b16 v[102:103], v13 offset:2560
    s_waitcnt lgkmcnt(8)
    v_mfma_f32_32x32x16_bf16 v[32:47], v[84:87], v[104:107], 0
    ds_read_b64_tr_b16 v[80:81], v14 offset:2048
    ds_read_b64_tr_b16 v[82:83], v14 offset:2560
    s_add_u32 s38, s36, s37
    s_add_u32 s37, s37, 2048
    s_and_b32 s37, s37, 32767
    buffer_load_dwordx4 v[120:123], v3, s[16:19], s38 offen offset:0 sc1
    s_waitcnt lgkmcnt(8)
    v_mfma_f32_32x32x16_bf16 v[48:63], v[88:91], v[104:107], 0
    ds_read_b64_tr_b16 v[84:85], v15 offset:2048
    ds_read_b64_tr_b16 v[86:87], v15 offset:2560
    s_waitcnt lgkmcnt(8)
    v_mfma_f32_32x32x16_bf16 v[64:79], v[92:95], v[104:107], 0
    ds_read_b64_tr_b16 v[88:89], v12 offset:8192
    ds_read_b64_tr_b16 v[90:91], v12 offset:8704
    buffer_load_dwordx4 v[124:127], v3, s[16:19], s38 offen offset:1024 sc1
    s_waitcnt vmcnt(4)
    s_waitcnt lgkmcnt(8)
    v_mfma_f32_32x32x16_bf16 v[16:31], v[96:99], v[108:111], v[16:31]
    ds_read_b64_tr_b16 v[92:93], v13 offset:8192
    ds_read_b64_tr_b16 v[94:95], v13 offset:8704
    s_waitcnt lgkmcnt(8)
    v_mfma_f32_32x32x16_bf16 v[32:47], v[100:103], v[108:111], v[32:47]
    ds_read_b64_tr_b16 v[96:97], v14 offset:8192
    ds_read_b64_tr_b16 v[98:99], v14 offset:8704
    s_add_u32 s38, s36, s37
    s_add_u32 s37, s37, 2048
    s_and_b32 s37, s37, 32767
    buffer_load_dwordx4 v[128:131], v3, s[16:19], s38 offen offset:0 sc1
    s_waitcnt lgkmcnt(8)
    v_mfma_f32_32x32x16_bf16 v[48:63], v[80:83], v[108:111], v[48:63]
    ds_read_b64_tr_b16 v[100:101], v15 offset:8192
    ds_read_b64_tr_b16 v[102:103], v15 offset:8704
    s_waitcnt lgkmcnt(8)
    v_mfma_f32_32x32x16_bf16 v[64:79], v[84:87], v[108:111], v[64:79]
    ds_read_b64_tr_b16 v[80:81], v12 offset:10240
    ds_read_b64_tr_b16 v[82:83], v12 offset:10752
    buffer_load_dwordx4 v[132:135], v3, s[16:19], s38 offen offset:1024 sc1
    s_waitcnt vmcnt(5)
    s_waitcnt lgkmcnt(8)
    v_mfma_f32_32x32x16_bf16 v[16:31], v[88:91], v[112:115], v[16:31]
    ds_read_b64_tr_b16 v[84:85], v13 offset:10240
    ds_read_b64_tr_b16 v[86:87], v13 offset:10752
    s_waitcnt lgkmcnt(8)
    v_mfma_f32_32x32x16_bf16 v[32:47], v[92:95], v[112:115], v[32:47]
    ds_read_b64_tr_b16 v[88:89], v14 offset:10240
    ds_read_b64_tr_b16 v[90:91], v14 offset:10752
    s_add_u32 s38, s36, s37
    s_add_u32 s37, s37, 2048
    s_and_b32 s37, s37, 32767
    buffer_load_dwordx4 v[136:139], v3, s[16:19], s38 offen offset:0 sc1
    s_waitcnt lgkmcnt(8)
    v_mfma_f32_32x32x16_bf16 v[48:63], v[96:99], v[112:115], v[48:63]
    ds_read_b64_tr_b16 v[92:93], v15 offset:10240
    ds_read_b64_tr_b16 v[94:95], v15 offset:10752
    s_waitcnt lgkmcnt(8)
    v_mfma_f32_32x32x16_bf16 v[64:79], v[100:103], v[112:115], v[64:79]
    ds_read_b64_tr_b16 v[96:97], v12 offset:16384
    ds_read_b64_tr_b16 v[98:99], v12 offset:16896
    buffer_load_dwordx4 v[140:143], v3, s[16:19], s38 offen offset:1024 sc1
    s_waitcnt vmcnt(6)
    s_waitcnt lgkmcnt(8)
    v_mfma_f32_32x32x16_bf16 v[16:31], v[80:83], v[116:119], v[16:31]
    ds_read_b64_tr_b16 v[100:101], v13 offset:16384
    ds_read_b64_tr_b16 v[102:103], v13 offset:16896
    s_waitcnt lgkmcnt(8)
    v_mfma_f32_32x32x16_bf16 v[32:47], v[84:87], v[116:119], v[32:47]
    ds_read_b64_tr_b16 v[80:81], v14 offset:16384
    ds_read_b64_tr_b16 v[82:83], v14 offset:16896
    s_add_u32 s38, s36, s37
    s_add_u32 s37, s37, 2048
    s_and_b32 s37, s37, 32767
    buffer_load_dwordx4 v[144:147], v3, s[16:19], s38 offen offset:0 sc1
    s_waitcnt lgkmcnt(8)
    v_mfma_f32_32x32x16_bf16 v[48:63], v[88:91], v[116:119], v[48:63]
    ds_read_b64_tr_b16 v[84:85], v15 offset:16384
    ds_read_b64_tr_b16 v[86:87], v15 offset:16896
    s_waitcnt lgkmcnt(8)
    v_mfma_f32_32x32x16_bf16 v[64:79], v[92:95], v[116:119], v[64:79]
    ds_read_b64_tr_b16 v[88:89], v12 offset:18432
    ds_read_b64_tr_b16 v[90:91], v12 offset:18944
    buffer_load_dwordx4 v[148:151], v3, s[16:19], s38 offen offset:1024 sc1
    s_waitcnt vmcnt(7)
    s_waitcnt lgkmcnt(8)
    v_mfma_f32_32x32x16_bf16 v[16:31], v[96:99], v[120:123], v[16:31]
    ds_read_b64_tr_b16 v[92:93], v13 offset:18432
    ds_read_b64_tr_b16 v[94:95], v13 offset:18944
    s_waitcnt lgkmcnt(8)
    v_mfma_f32_32x32x16_bf16 v[32:47], v[100:103], v[120:123], v[32:47]
    ds_read_b64_tr_b16 v[96:97], v14 offset:18432
    ds_read_b64_tr_b16 v[98:99], v14 offset:18944
    s_add_u32 s38, s36, s37
    s_add_u32 s37, s37, 2048
    s_and_b32 s37, s37, 32767
    buffer_load_dwordx4 v[104:107], v3, s[16:19], s38 offen offset:0 sc1
    s_waitcnt lgkmcnt(8)
    v_mfma_f32_32x32x16_bf16 v[48:63], v[80:83], v[120:123], v[48:63]
    ds_read_b64_tr_b16 v[100:101], v15 offset:18432
    ds_read_b64_tr_b16 v[102:103], v15 offset:18944
    s_waitcnt lgkmcnt(8)
    v_mfma_f32_32x32x16_bf16 v[64:79], v[84:87], v[120:123], v[64:79]
    ds_read_b64_tr_b16 v[80:81], v12 offset:24576
    ds_read_b64_tr_b16 v[82:83], v12 offset:25088
    buffer_load_dwordx4 v[108:111], v3, s[16:19], s38 offen offset:1024 sc1
    s_waitcnt vmcnt(8)
    s_waitcnt lgkmcnt(8)
    v_mfma_f32_32x32x16_bf16 v[16:31], v[88:91], v[124:127], v[16:31]
    ds_read_b64_tr_b16 v[84:85], v13 offset:24576
    ds_read_b64_tr_b16 v[86:87], v13 offset:25088
    s_waitcnt lgkmcnt(8)
    v_mfma_f32_32x32x16_bf16 v[32:47], v[92:95], v[124:127], v[32:47]
    ds_read_b64_tr_b16 v[88:89], v14 offset:24576
    ds_read_b64_tr_b16 v[90:91], v14 offset:25088
    s_add_u32 s38, s36, s37
    s_add_u32 s37, s37, 2048
    s_and_b32 s37, s37, 32767
    buffer_load_dwordx4 v[112:115], v3, s[16:19], s38 offen offset:0 sc1
    s_waitcnt lgkmcnt(8)
    v_mfma_f32_32x32x16_bf16 v[48:63], v[96:99], v[124:127], v[48:63]
    ds_read_b64_tr_b16 v[92:93], v15 offset:24576
    ds_read_b64_tr_b16 v[94:95], v15 offset:25088
    s_waitcnt lgkmcnt(8)
    v_mfma_f32_32x32x16_bf16 v[64:79], v[100:103], v[124:127], v[64:79]
    ds_read_b64_tr_b16 v[96:97], v12 offset:26624
    ds_read_b64_tr_b16 v[98:99], v12 offset:27136
    buffer_load_dwordx4 v[116:119], v3, s[16:19], s38 offen offset:1024 sc1
    s_waitcnt vmcnt(9)
    s_waitcnt lgkmcnt(8)
    v_mfma_f32_32x32x16_bf16 v[16:31], v[80:83], v[128:131], v[16:31]
    ds_read_b64_tr_b16 v[100:101], v13 offset:26624
    ds_read_b64_tr_b16 v[102:103], v13 offset:27136
    s_waitcnt lgkmcnt(8)
    v_mfma_f32_32x32x16_bf16 v[32:47], v[84:87], v[128:131], v[32:47]
    ds_read_b64_tr_b16 v[80:81], v14 offset:26624
    ds_read_b64_tr_b16 v[82:83], v14 offset:27136
    s_add_u32 s38, s36, s37
    s_add_u32 s37, s37, 2048
    s_and_b32 s37, s37, 32767
    buffer_load_dwordx4 v[120:123], v3, s[16:19], s38 offen offset:0 sc1
    s_waitcnt lgkmcnt(8)
    v_mfma_f32_32x32x16_bf16 v[48:63], v[88:91], v[128:131], v[48:63]
    ds_read_b64_tr_b16 v[84:85], v15 offset:26624
    ds_read_b64_tr_b16 v[86:87], v15 offset:27136
    s_waitcnt lgkmcnt(8)
    v_mfma_f32_32x32x16_bf16 v[64:79], v[92:95], v[128:131], v[64:79]
    ds_read_b64_tr_b16 v[88:89], v12 offset:32768
    ds_read_b64_tr_b16 v[90:91], v12 offset:33280
    buffer_load_dwordx4 v[124:127], v3, s[16:19], s38 offen offset:1024 sc1
    s_waitcnt vmcnt(10)
    s_waitcnt lgkmcnt(8)
    v_mfma_f32_32x32x16_bf16 v[16:31], v[96:99], v[132:135], v[16:31]
    ds_read_b64_tr_b16 v[92:93], v13 offset:32768
    ds_read_b64_tr_b16 v[94:95], v13 offset:33280
    s_waitcnt lgkmcnt(8)
    v_mfma_f32_32x32x16_bf16 v[32:47], v[100:103], v[132:135], v[32:47]
    ds_read_b64_tr_b16 v[96:97], v14 offset:32768
    ds_read_b64_tr_b16 v[98:99], v14 offset:33280
    s_waitcnt lgkmcnt(8)
    v_mfma_f32_32x32x16_bf16 v[48:63], v[80:83], v[132:135], v[48:63]
    ds_read_b64_tr_b16 v[100:101], v15 offset:32768
    ds_read_b64_tr_b16 v[102:103], v15 offset:33280
    s_waitcnt lgkmcnt(8)
    v_mfma_f32_32x32x16_bf16 v[64:79], v[84:87], v[132:135], v[64:79]
    ds_read_b64_tr_b16 v[80:81], v12 offset:34816
    ds_read_b64_tr_b16 v[82:83], v12 offset:35328
    s_add_u32 s38, s36, s37
    s_add_u32 s37, s37, 2048
    s_and_b32 s37, s37, 32767
    buffer_load_dwordx4 v[128:131], v3, s[16:19], s38 offen offset:0 sc1
    s_mov_b64 exec, 1
    ds_add_u32 v0, v2 offset:0
    s_mov_b64 exec, -1
    s_waitcnt vmcnt(10)
    s_waitcnt lgkmcnt(9)
    v_mfma_f32_32x32x16_bf16 v[16:31], v[88:91], v[136:139], v[16:31]
    ds_read_b64_tr_b16 v[84:85], v13 offset:34816
    ds_read_b64_tr_b16 v[86:87], v13 offset:35328
    s_waitcnt lgkmcnt(9)
    v_mfma_f32_32x32x16_bf16 v[32:47], v[92:95], v[136:139], v[32:47]
    ds_read_b64_tr_b16 v[88:89], v14 offset:34816
    ds_read_b64_tr_b16 v[90:91], v14 offset:35328
    s_waitcnt lgkmcnt(9)
    v_mfma_f32_32x32x16_bf16 v[48:63], v[96:99], v[136:139], v[48:63]
    ds_read_b64_tr_b16 v[92:93], v15 offset:34816
    ds_read_b64_tr_b16 v[94:95], v15 offset:35328
    buffer_load_dwordx2 v[152:153], v5, s[16:19], s39 offen offset:0 sc1
    s_waitcnt lgkmcnt(9)
    v_mfma_f32_32x32x16_bf16 v[64:79], v[100:103], v[136:139], v[64:79]
    ds_read_b64_tr_b16 v[96:97], v12 offset:40960
    ds_read_b64_tr_b16 v[98:99], v12 offset:41472
    buffer_load_dwordx4 v[132:135], v3, s[16:19], s38 offen offset:1024 sc1
    s_waitcnt vmcnt(11)
    s_waitcnt lgkmcnt(9)
    v_mfma_f32_32x32x16_bf16 v[16:31], v[80:83], v[140:143], v[16:31]
    ds_read_b64_tr_b16 v[100:101], v13 offset:40960
    ds_read_b64_tr_b16 v[102:103], v13 offset:41472
    s_waitcnt lgkmcnt(8)
    v_mfma_f32_32x32x16_bf16 v[32:47], v[84:87], v[140:143], v[32:47]
    ds_read_b64_tr_b16 v[80:81], v14 offset:40960
    ds_read_b64_tr_b16 v[82:83], v14 offset:41472
    s_waitcnt lgkmcnt(8)
    v_mfma_f32_32x32x16_bf16 v[48:63], v[88:91], v[140:143], v[48:63]
    ds_read_b64_tr_b16 v[84:85], v15 offset:40960
    ds_read_b64_tr_b16 v[86:87], v15 offset:41472
    buffer_load_dwordx2 v[154:155], v5, s[16:19], s39 offen offset:256 sc1
    s_waitcnt lgkmcnt(8)
    v_mfma_f32_32x32x16_bf16 v[64:79], v[92:95], v[140:143], v[64:79]
    ds_read_b64_tr_b16 v[88:89], v12 offset:43008
    ds_read_b64_tr_b16 v[90:91], v12 offset:43520
    s_add_u32 s38, s36, s37
    s_add_u32 s37, s37, 2048
    s_and_b32 s37, s37, 32767
    buffer_load_dwordx4 v[136:139], v3, s[16:19], s38 offen offset:0 sc1
    s_waitcnt vmcnt(12)
    s_waitcnt lgkmcnt(8)
    v_mfma_f32_32x32x16_bf16 v[16:31], v[96:99], v[144:147], v[16:31]
    ds_read_b64_tr_b16 v[92:93], v13 offset:43008
    ds_read_b64_tr_b16 v[94:95], v13 offset:43520
    s_waitcnt lgkmcnt(8)
    v_mfma_f32_32x32x16_bf16 v[32:47], v[100:103], v[144:147], v[32:47]
    ds_read_b64_tr_b16 v[96:97], v14 offset:43008
    ds_read_b64_tr_b16 v[98:99], v14 offset:43520
    s_waitcnt lgkmcnt(8)
    v_mfma_f32_32x32x16_bf16 v[48:63], v[80:83], v[144:147], v[48:63]
    ds_read_b64_tr_b16 v[100:101], v15 offset:43008
    ds_read_b64_tr_b16 v[102:103], v15 offset:43520
    buffer_load_dwordx2 v[156:157], v5, s[16:19], s39 offen offset:512 sc1
    s_waitcnt lgkmcnt(8)
    v_mfma_f32_32x32x16_bf16 v[64:79], v[84:87], v[144:147], v[64:79]
    ds_read_b64_tr_b16 v[80:81], v12 offset:49152
    ds_read_b64_tr_b16 v[82:83], v12 offset:49664
    buffer_load_dwordx4 v[140:143], v3, s[16:19], s38 offen offset:1024 sc1
    s_waitcnt vmcnt(13)
    s_waitcnt lgkmcnt(8)
    v_mfma_f32_32x32x16_bf16 v[16:31], v[88:91], v[148:151], v[16:31]
    ds_read_b64_tr_b16 v[84:85], v13 offset:49152
    ds_read_b64_tr_b16 v[86:87], v13 offset:49664
    s_waitcnt lgkmcnt(8)
    v_mfma_f32_32x32x16_bf16 v[32:47], v[92:95], v[148:151], v[32:47]
    ds_read_b64_tr_b16 v[88:89], v14 offset:49152
    ds_read_b64_tr_b16 v[90:91], v14 offset:49664
    s_waitcnt lgkmcnt(8)
    v_mfma_f32_32x32x16_bf16 v[48:63], v[96:99], v[148:151], v[48:63]
    ds_read_b64_tr_b16 v[92:93], v15 offset:49152
    ds_read_b64_tr_b16 v[94:95], v15 offset:49664
    buffer_load_dwordx2 v[158:159], v5, s[16:19], s39 offen offset:768 sc1
    s_waitcnt lgkmcnt(8)
    v_mfma_f32_32x32x16_bf16 v[64:79], v[100:103], v[148:151], v[64:79]
    ds_read_b64_tr_b16 v[96:97], v12 offset:51200
    ds_read_b64_tr_b16 v[98:99], v12 offset:51712
    s_add_u32 s38, s36, s37
    s_add_u32 s37, s37, 2048
    s_and_b32 s37, s37, 32767
    buffer_load_dwordx4 v[144:147], v3, s[16:19], s38 offen offset:0 sc1
    s_waitcnt vmcnt(14)
    s_waitcnt lgkmcnt(8)
    v_mfma_f32_32x32x16_bf16 v[16:31], v[80:83], v[104:107], v[16:31]
    ds_read_b64_tr_b16 v[100:101], v13 offset:51200
    ds_read_b64_tr_b16 v[102:103], v13 offset:51712
    s_waitcnt lgkmcnt(8)
    v_mfma_f32_32x32x16_bf16 v[32:47], v[84:87], v[104:107], v[32:47]
    ds_read_b64_tr_b16 v[80:81], v14 offset:51200
    ds_read_b64_tr_b16 v[82:83], v14 offset:51712
    s_waitcnt lgkmcnt(8)
    v_mfma_f32_32x32x16_bf16 v[48:63], v[88:91], v[104:107], v[48:63]
    ds_read_b64_tr_b16 v[84:85], v15 offset:51200
    ds_read_b64_tr_b16 v[86:87], v15 offset:51712
    buffer_load_dwordx2 v[160:161], v5, s[16:19], s39 offen offset:1024 sc1
    s_waitcnt lgkmcnt(8)
    v_mfma_f32_32x32x16_bf16 v[64:79], v[92:95], v[104:107], v[64:79]
    ds_read_b64_tr_b16 v[88:89], v12 offset:57344
    ds_read_b64_tr_b16 v[90:91], v12 offset:57856
    buffer_load_dwordx4 v[148:151], v3, s[16:19], s38 offen offset:1024 sc1
    s_waitcnt vmcnt(15)
    s_waitcnt lgkmcnt(8)
    v_mfma_f32_32x32x16_bf16 v[16:31], v[96:99], v[108:111], v[16:31]
    ds_read_b64_tr_b16 v[92:93], v13 offset:57344
    ds_read_b64_tr_b16 v[94:95], v13 offset:57856
    s_waitcnt lgkmcnt(8)
    v_mfma_f32_32x32x16_bf16 v[32:47], v[100:103], v[108:111], v[32:47]
    ds_read_b64_tr_b16 v[96:97], v14 offset:57344
    ds_read_b64_tr_b16 v[98:99], v14 offset:57856
    s_waitcnt lgkmcnt(8)
    v_mfma_f32_32x32x16_bf16 v[48:63], v[80:83], v[108:111], v[48:63]
    ds_read_b64_tr_b16 v[100:101], v15 offset:57344
    ds_read_b64_tr_b16 v[102:103], v15 offset:57856
    buffer_load_dwordx2 v[162:163], v5, s[16:19], s39 offen offset:1280 sc1
    s_waitcnt lgkmcnt(8)
    v_mfma_f32_32x32x16_bf16 v[64:79], v[84:87], v[108:111], v[64:79]
    ds_read_b64_tr_b16 v[80:81], v12 offset:59392
    ds_read_b64_tr_b16 v[82:83], v12 offset:59904
    s_add_u32 s38, s36, s37
    s_add_u32 s37, s37, 2048
    s_and_b32 s37, s37, 32767
    buffer_load_dwordx4 v[104:107], v3, s[16:19], s38 offen offset:0 sc1
    s_waitcnt vmcnt(16)
    s_waitcnt lgkmcnt(8)
    v_mfma_f32_32x32x16_bf16 v[16:31], v[88:91], v[112:115], v[16:31]
    ds_read_b64_tr_b16 v[84:85], v13 offset:59392
    ds_read_b64_tr_b16 v[86:87], v13 offset:59904
    s_waitcnt lgkmcnt(8)
    v_mfma_f32_32x32x16_bf16 v[32:47], v[92:95], v[112:115], v[32:47]
    ds_read_b64_tr_b16 v[88:89], v14 offset:59392
    ds_read_b64_tr_b16 v[90:91], v14 offset:59904
    s_waitcnt lgkmcnt(8)
    v_mfma_f32_32x32x16_bf16 v[48:63], v[96:99], v[112:115], v[48:63]
    ds_read_b64_tr_b16 v[92:93], v15 offset:59392
    ds_read_b64_tr_b16 v[94:95], v15 offset:59904
    buffer_load_dwordx2 v[164:165], v5, s[16:19], s39 offen offset:1536 sc1
    s_waitcnt lgkmcnt(8)
    v_mfma_f32_32x32x16_bf16 v[64:79], v[100:103], v[112:115], v[64:79]
    v_add_u32 v12, 65536, v12
    ds_read_b64_tr_b16 v[96:97], v12 offset:0
    ds_read_b64_tr_b16 v[98:99], v12 offset:512
    buffer_load_dwordx4 v[108:111], v3, s[16:19], s38 offen offset:1024 sc1
    s_waitcnt vmcnt(17)
    s_waitcnt lgkmcnt(8)
    v_mfma_f32_32x32x16_bf16 v[16:31], v[80:83], v[116:119], v[16:31]
    v_add_u32 v13, 65536, v13
    ds_read_b64_tr_b16 v[100:101], v13 offset:0
    ds_read_b64_tr_b16 v[102:103], v13 offset:512
    s_waitcnt lgkmcnt(8)
    v_mfma_f32_32x32x16_bf16 v[32:47], v[84:87], v[116:119], v[32:47]
    v_add_u32 v14, 65536, v14
    ds_read_b64_tr_b16 v[80:81], v14 offset:0
    ds_read_b64_tr_b16 v[82:83], v14 offset:512
    s_waitcnt lgkmcnt(8)
    v_mfma_f32_32x32x16_bf16 v[48:63], v[88:91], v[116:119], v[48:63]
    v_add_u32 v15, 65536, v15
    ds_read_b64_tr_b16 v[84:85], v15 offset:0
    ds_read_b64_tr_b16 v[86:87], v15 offset:512
    buffer_load_dwordx2 v[166:167], v5, s[16:19], s39 offen offset:1792 sc1
    s_waitcnt lgkmcnt(8)
    v_mfma_f32_32x32x16_bf16 v[64:79], v[92:95], v[116:119], v[64:79]
    ds_read_b64_tr_b16 v[88:89], v12 offset:2048
    ds_read_b64_tr_b16 v[90:91], v12 offset:2560
    s_add_u32 s38, s36, s37
    s_add_u32 s37, s37, 2048
    s_and_b32 s37, s37, 32767
    buffer_load_dwordx4 v[112:115], v3, s[16:19], s38 offen offset:0 sc1
    s_mov_b64 exec, 1
    ds_add_u32 v0, v2 offset:4
    s_mov_b64 exec, -1
    s_waitcnt vmcnt(18)
    s_waitcnt lgkmcnt(9)
    v_mfma_f32_32x32x16_bf16 v[16:31], v[96:99], v[120:123], v[16:31]
    ds_read_b64_tr_b16 v[92:93], v13 offset:2048
    ds_read_b64_tr_b16 v[94:95], v13 offset:2560
    s_waitcnt lgkmcnt(9)
    v_mfma_f32_32x32x16_bf16 v[32:47], v[100:103], v[120:123], v[32:47]
    ds_read_b64_tr_b16 v[96:97], v14 offset:2048
    ds_read_b64_tr_b16 v[98:99], v14 offset:2560
    s_waitcnt lgkmcnt(9)
    v_mfma_f32_32x32x16_bf16 v[48:63], v[80:83], v[120:123], v[48:63]
    ds_read_b64_tr_b16 v[100:101], v15 offset:2048
    ds_read_b64_tr_b16 v[102:103], v15 offset:2560
    s_waitcnt lgkmcnt(9)
    v_mfma_f32_32x32x16_bf16 v[64:79], v[84:87], v[120:123], v[64:79]
    v_mov_b32 v8, 163348
    s_mov_b32 s57, 0
km_spinW2:
    ds_read_b32 v9, v8
    s_waitcnt lgkmcnt(0)
    v_readfirstlane_b32 s56, v9
    s_nop 0
    s_cmp_ge_u32 s56, 4
    s_cbranch_scc1 km_spinW2_ok
    s_sleep 1
    s_add_u32 s57, s57, 1
    s_cmp_lt_u32 s57, 2097152
    s_cbranch_scc1 km_spinW2
km_spinW2_ok:
    ds_read_b64_tr_b16 v[80:81], v12 offset:8192
    ds_read_b64_tr_b16 v[82:83], v12 offset:8704
    buffer_load_dwordx4 v[116:119], v3, s[16:19], s38 offen offset:1024 sc1
    s_waitcnt vmcnt(18)
    s_waitcnt lgkmcnt(10)
    v_mfma_f32_32x32x16_bf16 v[16:31], v[88:91], v[124:127], v[16:31]
    ds_read_b64_tr_b16 v[84:85], v13 offset:8192
    ds_read_b64_tr_b16 v[86:87], v13 offset:8704
    s_waitcnt lgkmcnt(9)
    v_mfma_f32_32x32x16_bf16 v[32:47], v[92:95], v[124:127], v[32:47]
    ds_read_b64_tr_b16 v[88:89], v14 offset:8192
    ds_read_b64_tr_b16 v[90:91], v14 offset:8704
    s_waitcnt lgkmcnt(9)
    v_mfma_f32_32x32x16_bf16 v[48:63], v[96:99], v[124:127], v[48:63]
    ds_read_b64_tr_b16 v[92:93], v15 offset:8192
    ds_read_b64_tr_b16 v[94:95], v15 offset:8704
    v_mov_b32 v10, 0
    buffer_load_dword v11, v10, s[16:19], s34 offen sc1
    s_waitcnt lgkmcnt(9)
    v_mfma_f32_32x32x16_bf16 v[64:79], v[100:103], v[124:127], v[64:79]
    ds_read_b64_tr_b16 v[96:97], v12 offset:10240
    ds_read_b64_tr_b16 v[98:99], v12 offset:10752
    s_add_u32 s38, s36, s37
    s_add_u32 s37, s37, 2048
    s_and_b32 s37, s37, 32767
    buffer_load_dwordx4 v[120:123], v3, s[16:19], s38 offen offset:0 sc1
    s_waitcnt vmcnt(19)
    s_waitcnt lgkmcnt(8)
    v_mfma_f32_32x32x16_bf16 v[16:31], v[80:83], v[128:131], v[16:31]
    ds_read_b64_tr_b16 v[100:101], v13 offset:10240
    ds_read_b64_tr_b16 v[102:103], v13 offset:10752
    s_waitcnt lgkmcnt(8)
    v_mfma_f32_32x32x16_bf16 v[32:47], v[84:87], v[128:131], v[32:47]
    ds_read_b64_tr_b16 v[80:81], v14 offset:10240
    ds_read_b64_tr_b16 v[82:83], v14 offset:10752
    s_waitcnt lgkmcnt(8)
    v_mfma_f32_32x32x16_bf16 v[48:63], v[88:91], v[128:131], v[48:63]
    ds_read_b64_tr_b16 v[84:85], v15 offset:10240
    ds_read_b64_tr_b16 v[86:87], v15 offset:10752
    s_waitcnt lgkmcnt(8)
    v_mfma_f32_32x32x16_bf16 v[64:79], v[92:95], v[128:131], v[64:79]
    ds_read_b64_tr_b16 v[88:89], v12 offset:16384
    ds_read_b64_tr_b16 v[90:91], v12 offset:16896
    buffer_load_dwordx4 v[124:127], v3, s[16:19], s38 offen offset:1024 sc1
    s_waitcnt vmcnt(18)
    s_waitcnt lgkmcnt(8)
    v_mfma_f32_32x32x16_bf16 v[16:31], v[96:99], v[132:135], v[16:31]
    ds_read_b64_tr_b16 v[92:93], v13 offset:16384
    ds_read_b64_tr_b16 v[94:95], v13 offset:16896
    s_waitcnt lgkmcnt(8)
    v_mfma_f32_32x32x16_bf16 v[32:47], v[100:103], v[132:135], v[32:47]
    ds_read_b64_tr_b16 v[96:97], v14 offset:16384
    ds_read_b64_tr_b16 v[98:99], v14 offset:16896
    s_waitcnt lgkmcnt(8)
    v_mfma_f32_32x32x16_bf16 v[48:63], v[80:83], v[132:135], v[48:63]
    ds_read_b64_tr_b16 v[100:101], v15 offset:16384
    ds_read_b64_tr_b16 v[102:103], v15 offset:16896
    s_waitcnt lgkmcnt(8)
    v_mfma_f32_32x32x16_bf16 v[64:79], v[84:87], v[132:135], v[64:79]
    ds_read_b64_tr_b16 v[80:81], v12 offset:18432
    ds_read_b64_tr_b16 v[82:83], v12 offset:18944
    s_add_u32 s38, s36, s37
    s_add_u32 s37, s37, 2048
    s_and_b32 s37, s37, 32767
    buffer_load_dwordx4 v[128:131], v3, s[16:19], s38 offen offset:0 sc1
    s_waitcnt vmcnt(17)
    s_waitcnt lgkmcnt(8)
    v_mfma_f32_32x32x16_bf16 v[16:31], v[88:91], v[136:139], v[16:31]
    ds_read_b64_tr_b16 v[84:85], v13 offset:18432
    ds_read_b64_tr_b16 v[86:87], v13 offset:18944
    s_waitcnt lgkmcnt(8)
    v_mfma_f32_32x32x16_bf16 v[32:47], v[92:95], v[136:139], v[32:47]
    ds_read_b64_tr_b16 v[88:89], v14 offset:18432
    ds_read_b64_tr_b16 v[90:91], v14 offset:18944
    s_waitcnt lgkmcnt(8)
    v_mfma_f32_32x32x16_bf16 v[48:63], v[96:99], v[136:139], v[48:63]
    ds_read_b64_tr_b16 v[92:93], v15 offset:18432
    ds_read_b64_tr_b16 v[94:95], v15 offset:18944
    s_waitcnt lgkmcnt(8)
    v_mfma_f32_32x32x16_bf16 v[64:79], v[100:103], v[136:139], v[64:79]
    ds_read_b64_tr_b16 v[96:97], v12 offset:24576
    ds_read_b64_tr_b16 v[98:99], v12 offset:25088
    buffer_load_dwordx4 v[132:135], v3, s[16:19], s38 offen offset:1024 sc1
    s_waitcnt vmcnt(16)
    s_waitcnt lgkmcnt(8)
    v_mfma_f32_32x32x16_bf16 v[16:31], v[80:83], v[140:143], v[16:31]
    ds_read_b64_tr_b16 v[100:101], v13 offset:24576
    ds_read_b64_tr_b16 v[102:103], v13 offset:25088
    s_waitcnt lgkmcnt(8)
    v_mfma_f32_32x32x16_bf16 v[32:47], v[84:87], v[140:143], v[32:47]
    ds_read_b64_tr_b16 v[80:81], v14 offset:24576
    ds_read_b64_tr_b16 v[82:83], v14 offset:25088
    s_waitcnt lgkmcnt(8)
    v_mfma_f32_32x32x16_bf16 v[48:63], v[88:91], v[140:143], v[48:63]
    ds_read_b64_tr_b16 v[84:85], v15 offset:24576
    ds_read_b64_tr_b16 v[86:87], v15 offset:25088
    s_waitcnt lgkmcnt(8)
    v_mfma_f32_32x32x16_bf16 v[64:79], v[92:95], v[140:143], v[64:79]
    ds_read_b64_tr_b16 v[88:89], v12 offset:26624
    ds_read_b64_tr_b16 v[90:91], v12 offset:27136
    s_waitcnt vmcnt(14)
    s_waitcnt lgkmcnt(8)
    v_mfma_f32_32x32x16_bf16 v[16:31], v[96:99], v[144:147], v[16:31]
    ds_read_b64_tr_b16 v[92:93], v13 offset:26624
    ds_read_b64_tr_b16 v[94:95], v13 offset:27136
    s_waitcnt lgkmcnt(8)
    v_mfma_f32_32x32x16_bf16 v[32:47], v[100:103], v[144:147], v[32:47]
    ds_read_b64_tr_b16 v[96:97], v14 offset:26624
    ds_read_b64_tr_b16 v[98:99], v14 offset:27136
    s_waitcnt lgkmcnt(8)
    v_mfma_f32_32x32x16_bf16 v[48:63], v[80:83], v[144:147], v[48:63]
    ds_read_b64_tr_b16 v[100:101], v15 offset:26624
    ds_read_b64_tr_b16 v[102:103], v15 offset:27136
    s_waitcnt lgkmcnt(8)
    v_mfma_f32_32x32x16_bf16 v[64:79], v[84:87], v[144:147], v[64:79]
    ds_read_b64_tr_b16 v[80:81], v12 offset:32768
    ds_read_b64_tr_b16 v[82:83], v12 offset:33280
    s_waitcnt vmcnt(12)
    s_waitcnt lgkmcnt(8)
    v_mfma_f32_32x32x16_bf16 v[16:31], v[88:91], v[148:151], v[16:31]
    ds_read_b64_tr_b16 v[84:85], v13 offset:32768
    ds_read_b64_tr_b16 v[86:87], v13 offset:33280
    s_waitcnt lgkmcnt(8)
    v_mfma_f32_32x32x16_bf16 v[32:47], v[92:95], v[148:151], v[32:47]
    ds_read_b64_tr_b16 v[88:89], v14 offset:32768
    ds_read_b64_tr_b16 v[90:91], v14 offset:33280
    s_waitcnt lgkmcnt(8)
    v_mfma_f32_32x32x16_bf16 v[48:63], v[96:99], v[148:151], v[48:63]
    ds_read_b64_tr_b16 v[92:93], v15 offset:32768
    ds_read_b64_tr_b16 v[94:95], v15 offset:33280
    s_waitcnt lgkmcnt(8)
    v_mfma_f32_32x32x16_bf16 v[64:79], v[100:103], v[148:151], v[64:79]
    ds_read_b64_tr_b16 v[96:97], v12 offset:34816
    ds_read_b64_tr_b16 v[98:99], v12 offset:35328
    s_mov_b64 exec, 1
    ds_add_u32 v0, v2 offset:8
    s_mov_b64 exec, -1
    s_waitcnt vmcnt(10)
    s_waitcnt lgkmcnt(9)
    v_mfma_f32_32x32x16_bf16 v[16:31], v[80:83], v[104:107], v[16:31]
    ds_read_b64_tr_b16 v[100:101], v13 offset:34816
    ds_read_b64_tr_b16 v[102:103], v13 offset:35328
    s_waitcnt lgkmcnt(9)
    v_mfma_f32_32x32x16_bf16 v[32:47], v[84:87], v[104:107], v[32:47]
    ds_read_b64_tr_b16 v[80:81], v14 offset:34816
    ds_read_b64_tr_b16 v[82:83], v14 offset:35328
    s_waitcnt lgkmcnt(9)
    v_mfma_f32_32x32x16_bf16 v[48:63], v[88:91], v[104:107], v[48:63]
    ds_read_b64_tr_b16 v[84:85], v15 offset:34816
    ds_read_b64_tr_b16 v[86:87], v15 offset:35328
    s_waitcnt vmcnt(4)
    v_readfirstlane_b32 s56, v11
    s_nop 0
    s_cmp_lg_u32 s56, 0
    s_cbranch_scc1 km_fs_ok
    v_lshlrev_b32 v8, 2, v1
    s_mov_b32 s57, 0
    s_mov_b32 exec_lo, 0x1
    s_mov_b32 exec_hi, 0
km_pollS:
    buffer_load_dword v9, v8, s[16:19], s34 offen sc1
    s_waitcnt vmcnt(0)
    v_cmp_lt_u32 vcc, 0, v9
    s_nop 0
    s_cmp_eq_u32 vcc_lo, 0x1
    s_cbranch_scc1 km_pollS_ok
    s_sleep 2
    s_add_u32 s57, s57, 1
    s_cmp_lt_u32 s57, 131072
    s_cbranch_scc1 km_pollS
km_pollS_ok:
    s_mov_b64 exec, -1
km_fs_ok:
    s_waitcnt lgkmcnt(9)
    v_mfma_f32_32x32x16_bf16 v[64:79], v[92:95], v[104:107], v[64:79]
    ds_read_b64_tr_b16 v[88:89], v12 offset:40960
    ds_read_b64_tr_b16 v[90:91], v12 offset:41472
    s_waitcnt vmcnt(8)
    s_waitcnt lgkmcnt(9)
    v_mfma_f32_32x32x16_bf16 v[16:31], v[96:99], v[108:111], v[16:31]
    ds_read_b64_tr_b16 v[92:93], v13 offset:40960
    ds_read_b64_tr_b16 v[94:95], v13 offset:41472
    s_waitcnt lgkmcnt(8)
    v_mfma_f32_32x32x16_bf16 v[32:47], v[100:103], v[108:111], v[32:47]
    ds_read_b64_tr_b16 v[96:97], v14 offset:40960
    ds_read_b64_tr_b16 v[98:99], v14 offset:41472
    s_waitcnt lgkmcnt(8)
    v_mfma_f32_32x32x16_bf16 v[48:63], v[80:83], v[108:111], v[48:63]
    ds_read_b64_tr_b16 v[100:101], v15 offset:40960
    ds_read_b64_tr_b16 v[102:103], v15 offset:41472
    buffer_load_dwordx4 v[136:139], v7, s[16:19], s35 offen offset:0 sc1
    s_waitcnt lgkmcnt(8)
    v_mfma_f32_32x32x16_bf16 v[64:79], v[84:87], v[108:111], v[64:79]
    ds_read_b64_tr_b16 v[80:81], v12 offset:43008
    ds_read_b64_tr_b16 v[82:83], v12 offset:43520
    s_waitcnt vmcnt(7)
    s_waitcnt lgkmcnt(8)
    v_mfma_f32_32x32x16_bf16 v[16:31], v[88:91], v[112:115], v[16:31]
    ds_read_b64_tr_b16 v[84:85], v13 offset:43008
    ds_read_b64_tr_b16 v[86:87], v13 offset:43520
    s_waitcnt lgkmcnt(8)
    v_mfma_f32_32x32x16_bf16 v[32:47], v[92:95], v[112:115], v[32:47]
    ds_read_b64_tr_b16 v[88:89], v14 offset:43008
    ds_read_b64_tr_b16 v[90:91], v14 offset:43520
    s_waitcnt lgkmcnt(8)
    v_mfma_f32_32x32x16_bf16 v[48:63], v[96:99], v[112:115], v[48:63]
    ds_read_b64_tr_b16 v[92:93], v15 offset:43008
    ds_read_b64_tr_b16 v[94:95], v15 offset:43520
    buffer_load_dwordx4 v[140:143], v7, s[16:19], s35 offen offset:512 sc1
    s_waitcnt lgkmcnt(8)
    v_mfma_f32_32x32x16_bf16 v[64:79], v[100:103], v[112:115], v[64:79]
    ds_read_b64_tr_b16 v[96:97], v12 offset:49152
    ds_read_b64_tr_b16 v[98:99], v12 offset:49664
    s_waitcnt vmcnt(7)
    s_waitcnt lgkmcnt(8)
    v_mfma_f32_32x32x16_bf16 v[16:31], v[80:83], v[116:119], v[16:31]
    ds_read_b64_tr_b16 v[100:101], v13 offset:49152
    ds_read_b64_tr_b16 v[102:103], v13 offset:49664
    s_waitcnt lgkmcnt(8)
    v_mfma_f32_32x32x16_bf16 v[32:47], v[84:87], v[116:119], v[32:47]
    ds_read_b64_tr_b16 v[80:81], v14 offset:49152
    ds_read_b64_tr_b16 v[82:83], v14 offset:49664
    s_waitcnt lgkmcnt(8)
    v_mfma_f32_32x32x16_bf16 v[48:63], v[88:91], v[116:119], v[48:63]
    ds_read_b64_tr_b16 v[84:85], v15 offset:49152
    ds_read_b64_tr_b16 v[86:87], v15 offset:49664
    buffer_load_dwordx4 v[144:147], v7, s[16:19], s35 offen offset:1024 sc1
    s_waitcnt lgkmcnt(8)
    v_mfma_f32_32x32x16_bf16 v[64:79], v[92:95], v[116:119], v[64:79]
    ds_read_b64_tr_b16 v[88:89], v12 offset:51200
    ds_read_b64_tr_b16 v[90:91], v12 offset:51712
    s_waitcnt vmcnt(6)
    s_waitcnt lgkmcnt(8)
    v_mfma_f32_32x32x16_bf16 v[16:31], v[96:99], v[120:123], v[16:31]
    ds_read_b64_tr_b16 v[92:93], v13 offset:51200
    ds_read_b64_tr_b16 v[94:95], v13 offset:51712
    s_waitcnt lgkmcnt(8)
    v_mfma_f32_32x32x16_bf16 v[32:47], v[100:103], v[120:123], v[32:47]
    ds_read_b64_tr_b16 v[96:97], v14 offset:51200
    ds_read_b64_tr_b16 v[98:99], v14 offset:51712
    s_waitcnt lgkmcnt(8)
    v_mfma_f32_32x32x16_bf16 v[48:63], v[80:83], v[120:123], v[48:63]
    ds_read_b64_tr_b16 v[100:101], v15 offset:51200
    ds_read_b64_tr_b16 v[102:103], v15 offset:51712
    buffer_load_dwordx4 v[148:151], v7, s[16:19], s35 offen offset:1536 sc1
    s_waitcnt lgkmcnt(8)
    v_mfma_f32_32x32x16_bf16 v[64:79], v[84:87], v[120:123], v[64:79]
    ds_read_b64_tr_b16 v[80:81], v12 offset:57344
    ds_read_b64_tr_b16 v[82:83], v12 offset:57856
    s_waitcnt vmcnt(6)
    s_waitcnt lgkmcnt(8)
    v_mfma_f32_32x32x16_bf16 v[16:31], v[88:91], v[124:127], v[16:31]
    ds_read_b64_tr_b16 v[84:85], v13 offset:57344
    ds_read_b64_tr_b16 v[86:87], v13 offset:57856
    s_waitcnt lgkmcnt(8)
    v_mfma_f32_32x32x16_bf16 v[32:47], v[92:95], v[124:127], v[32:47]
    ds_read_b64_tr_b16 v[88:89], v14 offset:57344
    ds_read_b64_tr_b16 v[90:91], v14 offset:57856
    s_waitcnt lgkmcnt(8)
    v_mfma_f32_32x32x16_bf16 v[48:63], v[96:99], v[124:127], v[48:63]
    ds_read_b64_tr_b16 v[92:93], v15 offset:57344
    ds_read_b64_tr_b16 v[94:95], v15 offset:57856
    s_waitcnt lgkmcnt(8)
    v_mfma_f32_32x32x16_bf16 v[64:79], v[100:103], v[124:127], v[64:79]
    ds_read_b64_tr_b16 v[96:97], v12 offset:59392
    ds_read_b64_tr_b16 v[98:99], v12 offset:59904
    s_waitcnt vmcnt(5)
    s_waitcnt lgkmcnt(8)
    v_mfma_f32_32x32x16_bf16 v[16:31], v[80:83], v[128:131], v[16:31]
    ds_read_b64_tr_b16 v[100:101], v13 offset:59392
    ds_read_b64_tr_b16 v[102:103], v13 offset:59904
    s_waitcnt lgkmcnt(8)
    v_mfma_f32_32x32x16_bf16 v[32:47], v[84:87], v[128:131], v[32:47]
    ds_read_b64_tr_b16 v[80:81], v14 offset:59392
    ds_read_b64_tr_b16 v[82:83], v14 offset:59904
    s_waitcnt lgkmcnt(8)
    v_mfma_f32_32x32x16_bf16 v[48:63], v[88:91], v[128:131], v[48:63]
    ds_read_b64_tr_b16 v[84:85], v15 offset:59392
    ds_read_b64_tr_b16 v[86:87], v15 offset:59904
    s_waitcnt lgkmcnt(8)
    v_mfma_f32_32x32x16_bf16 v[64:79], v[92:95], v[128:131], v[64:79]
    s_waitcnt vmcnt(4)
    s_waitcnt lgkmcnt(6)
    v_mfma_f32_32x32x16_bf16 v[16:31], v[96:99], v[132:135], v[16:31]
    s_waitcnt lgkmcnt(4)
    v_mfma_f32_32x32x16_bf16 v[32:47], v[100:103], v[132:135], v[32:47]
    s_waitcnt lgkmcnt(2)
    v_mfma_f32_32x32x16_bf16 v[48:63], v[80:83], v[132:135], v[48:63]
    s_waitcnt lgkmcnt(0)
    v_mfma_f32_32x32x16_bf16 v[64:79], v[84:87], v[132:135], v[64:79]
    s_mov_b64 exec, 1
    ds_add_u32 v0, v2 offset:12
    s_mov_b64 exec, -1
    s_cmp_eq_u32 s27, 0
    s_cbranch_scc1 km_e_pa
    s_setprio 3
    s_branch km_e_pb
km_e_pa:
    s_setprio 3
km_e_pb:
    v_add_f32 v152, v152, v160
    v_add_f32 v153, v153, v161
    v_add_f32 v154, v154, v162
    v_add_f32 v155, v155, v163
    v_add_f32 v156, v156, v164
    v_add_f32 v157, v157, v165
    v_add_f32 v158, v158, v166
    v_add_f32 v159, v159, v167
    v_add_f32 v152, v152, v156
    v_add_f32 v153, v153, v157
    v_add_f32 v154, v154, v158
    v_add_f32 v155, v155, v159
    v_add_f32 v152, v152, v154
    v_add_f32 v153, v153, v155
    v_mov_b32 v154, v152
    v_mov_b32 v155, v153
    s_nop 0
    v_permlane32_swap_b32 v154, v152
    v_permlane32_swap_b32 v155, v153
    v_add_f32 v152, v152, v154
    v_add_f32 v153, v153, v155
    v_mul_f32 v10, 0xbb000000, v152
    v_mul_f32 v11, 0x3b000000, v153
    v_fma_f32 v11, -v10, v10, v11
    v_max_f32 v11, 0, v11
    v_add_f32 v11, 0x3727c5ac, v11
    v_rsq_f32 v8, v11
    v_sqrt_f32 v9, v11
    v_cvt_pk_bf16_f32 v152, v10, v10
    v_and_b32 v152, s46, v152
    v_sub_f32 v153, v10, v152
    v_cvt_pk_bf16_f32 v12, v152, v153
    v_cvt_pk_bf16_f32 v152, v9, v9
    v_and_b32 v152, s46, v152
    v_sub_f32 v153, v9, v152
    v_cvt_pk_bf16_f32 v14, v152, v153
    v_cmp_gt_u32 vcc, 32, v1
    s_nop 1
    v_cndmask_b32 v12, 0, v12, vcc
    v_cndmask_b32 v14, 0, v14, vcc
    v_mov_b32 v13, v12
    v_mov_b32 v15, v14
    v_mov_b32 v10, 0xc0135761
    v_mov_b32 v11, s44
    s_waitcnt vmcnt(0)
    v_mfma_f32_32x32x16_bf16 v[16:31], v[136:139], v[12:15], v[16:31]
    v_mfma_f32_32x32x16_bf16 v[32:47], v[140:143], v[12:15], v[32:47]
    v_mfma_f32_32x32x16_bf16 v[48:63], v[144:147], v[12:15], v[48:63]
    v_mfma_f32_32x32x16_bf16 v[64:79], v[148:151], v[12:15], v[64:79]
    s_nop 7
    s_nop 0
    v_mul_f32 v16, v8, v16
    v_mul_f32 v17, v8, v17
    v_mul_f32 v18, v8, v18
    v_mul_f32 v19, v8, v19
    v_mul_f32 v20, v8, v20
    v_mul_f32 v21, v8, v21
    v_mul_f32 v22, v8, v22
    v_mul_f32 v23, v8, v23
    v_mul_f32 v80, v16, v16
    v_mul_f32 v81, v17, v17
    v_mul_f32 v82, v18, v18
    v_mul_f32 v83, v19, v19
    v_mul_f32 v84, v20, v20
    v_mul_f32 v85, v21, v21
    v_mul_f32 v86, v22, v22
    v_mul_f32 v87, v23, v23
    v_fma_f32 v80, v80, s44, v10
    v_fma_f32 v81, v81, s44, v10
    v_fma_f32 v82, v82, s44, v10
    v_fma_f32 v83, v83, s44, v10
    v_fma_f32 v84, v84, s44, v10
    v_fma_f32 v85, v85, s44, v10
    v_fma_f32 v86, v86, s44, v10
    v_fma_f32 v87, v87, s44, v10
    v_mul_f32 v80, v80, v16
    v_mul_f32 v81, v81, v17
    v_mul_f32 v82, v82, v18
    v_mul_f32 v83, v83, v19
    v_mul_f32 v84, v84, v20
    v_mul_f32 v85, v85, v21
    v_mul_f32 v86, v86, v22
    v_mul_f32 v87, v87, v23
    v_exp_f32 v80, v80
    v_exp_f32 v81, v81
    v_exp_f32 v82, v82
    v_exp_f32 v83, v83
    v_exp_f32 v84, v84
    v_exp_f32 v85, v85
    v_exp_f32 v86, v86
    v_exp_f32 v87, v87
    v_mul_f32 v24, v24, v16
    v_mul_f32 v25, v25, v17
    v_mul_f32 v26, v26, v18
    v_mul_f32 v27, v27, v19
    v_mul_f32 v28, v28, v20
    v_mul_f32 v29, v29, v21
    v_mul_f32 v30, v30, v22
    v_mul_f32 v31, v31, v23
    v_fma_f32 v80, v80, v9, v9
    v_fma_f32 v81, v81, v9, v9
    v_fma_f32 v82, v82, v9, v9
    v_fma_f32 v83, v83, v9, v9
    v_fma_f32 v84, v84, v9, v9
    v_fma_f32 v85, v85, v9, v9
    v_fma_f32 v86, v86, v9, v9
    v_fma_f32 v87, v87, v9, v9
    v_rcp_f32 v80, v80
    v_rcp_f32 v81, v81
    v_rcp_f32 v82, v82
    v_rcp_f32 v83, v83
    v_rcp_f32 v84, v84
    v_rcp_f32 v85, v85
    v_rcp_f32 v86, v86
    v_rcp_f32 v87, v87
    v_mul_f32 v24, v24, v80
    v_mul_f32 v25, v25, v81
    v_mul_f32 v26, v26, v82
    v_mul_f32 v27, v27, v83
    v_mul_f32 v28, v28, v84
    v_mul_f32 v29, v29, v85
    v_mul_f32 v30, v30, v86
    v_mul_f32 v31, v31, v87
    v_cvt_pk_bf16_f32 v16, v24, v25
    v_cvt_pk_bf16_f32 v17, v26, v27
    v_cvt_pk_bf16_f32 v18, v28, v29
    v_cvt_pk_bf16_f32 v19, v30, v31
    buffer_store_dwordx4 v[16:19], v3, s[16:19], s40 offen offset:0 sc1
    v_mul_f32 v32, v8, v32
    v_mul_f32 v33, v8, v33
    v_mul_f32 v34, v8, v34
    v_mul_f32 v35, v8, v35
    v_mul_f32 v36, v8, v36
    v_mul_f32 v37, v8, v37
    v_mul_f32 v38, v8, v38
    v_mul_f32 v39, v8, v39
    v_mul_f32 v88, v32, v32
    v_mul_f32 v89, v33, v33
    v_mul_f32 v90, v34, v34
    v_mul_f32 v91, v35, v35
    v_mul_f32 v92, v36, v36
    v_mul_f32 v93, v37, v37
    v_mul_f32 v94, v38, v38
    v_mul_f32 v95, v39, v39
    v_fma_f32 v88, v88, s44, v10
    v_fma_f32 v89, v89, s44, v10
    v_fma_f32 v90, v90, s44, v10
    v_fma_f32 v91, v91, s44, v10
    v_fma_f32 v92, v92, s44, v10
    v_fma_f32 v93, v93, s44, v10
    v_fma_f32 v94, v94, s44, v10
    v_fma_f32 v95, v95, s44, v10
    v_mul_f32 v88, v88, v32
    v_mul_f32 v89, v89, v33
    v_mul_f32 v90, v90, v34
    v_mul_f32 v91, v91, v35
    v_mul_f32 v92, v92, v36
    v_mul_f32 v93, v93, v37
    v_mul_f32 v94, v94, v38
    v_mul_f32 v95, v95, v39
    v_exp_f32 v88, v88
    v_exp_f32 v89, v89
    v_exp_f32 v90, v90
    v_exp_f32 v91, v91
    v_exp_f32 v92, v92
    v_exp_f32 v93, v93
    v_exp_f32 v94, v94
    v_exp_f32 v95, v95
    v_mul_f32 v40, v40, v32
    v_mul_f32 v41, v41, v33
    v_mul_f32 v42, v42, v34
    v_mul_f32 v43, v43, v35
    v_mul_f32 v44, v44, v36
    v_mul_f32 v45, v45, v37
    v_mul_f32 v46, v46, v38
    v_mul_f32 v47, v47, v39
    v_fma_f32 v88, v88, v9, v9
    v_fma_f32 v89, v89, v9, v9
    v_fma_f32 v90, v90, v9, v9
    v_fma_f32 v91, v91, v9, v9
    v_fma_f32 v92, v92, v9, v9
    v_fma_f32 v93, v93, v9, v9
    v_fma_f32 v94, v94, v9, v9
    v_fma_f32 v95, v95, v9, v9
    v_rcp_f32 v88, v88
    v_rcp_f32 v89, v89
    v_rcp_f32 v90, v90
    v_rcp_f32 v91, v91
    v_rcp_f32 v92, v92
    v_rcp_f32 v93, v93
    v_rcp_f32 v94, v94
    v_rcp_f32 v95, v95
    v_mul_f32 v40, v40, v88
    v_mul_f32 v41, v41, v89
    v_mul_f32 v42, v42, v90
    v_mul_f32 v43, v43, v91
    v_mul_f32 v44, v44, v92
    v_mul_f32 v45, v45, v93
    v_mul_f32 v46, v46, v94
    v_mul_f32 v47, v47, v95
    v_cvt_pk_bf16_f32 v32, v40, v41
    v_cvt_pk_bf16_f32 v33, v42, v43
    v_cvt_pk_bf16_f32 v34, v44, v45
    v_cvt_pk_bf16_f32 v35, v46, v47
    buffer_store_dwordx4 v[32:35], v3, s[16:19], s40 offen offset:1024 sc1
    v_mul_f32 v48, v8, v48
    v_mul_f32 v49, v8, v49
    v_mul_f32 v50, v8, v50
    v_mul_f32 v51, v8, v51
    v_mul_f32 v52, v8, v52
    v_mul_f32 v53, v8, v53
    v_mul_f32 v54, v8, v54
    v_mul_f32 v55, v8, v55
    v_mul_f32 v80, v48, v48
    v_mul_f32 v81, v49, v49
    v_mul_f32 v82, v50, v50
    v_mul_f32 v83, v51, v51
    v_mul_f32 v84, v52, v52
    v_mul_f32 v85, v53, v53
    v_mul_f32 v86, v54, v54
    v_mul_f32 v87, v55, v55
    v_fma_f32 v80, v80, s44, v10
    v_fma_f32 v81, v81, s44, v10
    v_fma_f32 v82, v82, s44, v10
    v_fma_f32 v83, v83, s44, v10
    v_fma_f32 v84, v84, s44, v10
    v_fma_f32 v85, v85, s44, v10
    v_fma_f32 v86, v86, s44, v10
    v_fma_f32 v87, v87, s44, v10
    v_mul_f32 v80, v80, v48
    v_mul_f32 v81, v81, v49
    v_mul_f32 v82, v82, v50
    v_mul_f32 v83, v83, v51
    v_mul_f32 v84, v84, v52
    v_mul_f32 v85, v85, v53
    v_mul_f32 v86, v86, v54
    v_mul_f32 v87, v87, v55
    v_exp_f32 v80, v80
    v_exp_f32 v81, v81
    v_exp_f32 v82, v82
    v_exp_f32 v83, v83
    v_exp_f32 v84, v84
    v_exp_f32 v85, v85
    v_exp_f32 v86, v86
    v_exp_f32 v87, v87
    v_mul_f32 v56, v56, v48
    v_mul_f32 v57, v57, v49
    v_mul_f32 v58, v58, v50
    v_mul_f32 v59, v59, v51
    v_mul_f32 v60, v60, v52
    v_mul_f32 v61, v61, v53
    v_mul_f32 v62, v62, v54
    v_mul_f32 v63, v63, v55
    v_fma_f32 v80, v80, v9, v9
    v_fma_f32 v81, v81, v9, v9
    v_fma_f32 v82, v82, v9, v9
    v_fma_f32 v83, v83, v9, v9
    v_fma_f32 v84, v84, v9, v9
    v_fma_f32 v85, v85, v9, v9
    v_fma_f32 v86, v86, v9, v9
    v_fma_f32 v87, v87, v9, v9
    v_rcp_f32 v80, v80
    v_rcp_f32 v81, v81
    v_rcp_f32 v82, v82
    v_rcp_f32 v83, v83
    v_rcp_f32 v84, v84
    v_rcp_f32 v85, v85
    v_rcp_f32 v86, v86
    v_rcp_f32 v87, v87
    v_mul_f32 v56, v56, v80
    v_mul_f32 v57, v57, v81
    v_mul_f32 v58, v58, v82
    v_mul_f32 v59, v59, v83
    v_mul_f32 v60, v60, v84
    v_mul_f32 v61, v61, v85
    v_mul_f32 v62, v62, v86
    v_mul_f32 v63, v63, v87
    v_cvt_pk_bf16_f32 v48, v56, v57
    v_cvt_pk_bf16_f32 v49, v58, v59
    v_cvt_pk_bf16_f32 v50, v60, v61
    v_cvt_pk_bf16_f32 v51, v62, v63
    buffer_store_dwordx4 v[48:51], v3, s[16:19], s40 offen offset:2048 sc1
    v_mul_f32 v64, v8, v64
    v_mul_f32 v65, v8, v65
    v_mul_f32 v66, v8, v66
    v_mul_f32 v67, v8, v67
    v_mul_f32 v68, v8, v68
    v_mul_f32 v69, v8, v69
    v_mul_f32 v70, v8, v70
    v_mul_f32 v71, v8, v71
    v_mul_f32 v88, v64, v64
    v_mul_f32 v89, v65, v65
    v_mul_f32 v90, v66, v66
    v_mul_f32 v91, v67, v67
    v_mul_f32 v92, v68, v68
    v_mul_f32 v93, v69, v69
    v_mul_f32 v94, v70, v70
    v_mul_f32 v95, v71, v71
    v_fma_f32 v88, v88, s44, v10
    v_fma_f32 v89, v89, s44, v10
    v_fma_f32 v90, v90, s44, v10
    v_fma_f32 v91, v91, s44, v10
    v_fma_f32 v92, v92, s44, v10
    v_fma_f32 v93, v93, s44, v10
    v_fma_f32 v94, v94, s44, v10
    v_fma_f32 v95, v95, s44, v10
    v_mul_f32 v88, v88, v64
    v_mul_f32 v89, v89, v65
    v_mul_f32 v90, v90, v66
    v_mul_f32 v91, v91, v67
    v_mul_f32 v92, v92, v68
    v_mul_f32 v93, v93, v69
    v_mul_f32 v94, v94, v70
    v_mul_f32 v95, v95, v71
    v_exp_f32 v88, v88
    v_exp_f32 v89, v89
    v_exp_f32 v90, v90
    v_exp_f32 v91, v91
    v_exp_f32 v92, v92
    v_exp_f32 v93, v93
    v_exp_f32 v94, v94
    v_exp_f32 v95, v95
    v_mul_f32 v72, v72, v64
    v_mul_f32 v73, v73, v65
    v_mul_f32 v74, v74, v66
    v_mul_f32 v75, v75, v67
    v_mul_f32 v76, v76, v68
    v_mul_f32 v77, v77, v69
    v_mul_f32 v78, v78, v70
    v_mul_f32 v79, v79, v71
    v_fma_f32 v88, v88, v9, v9
    v_fma_f32 v89, v89, v9, v9
    v_fma_f32 v90, v90, v9, v9
    v_fma_f32 v91, v91, v9, v9
    v_fma_f32 v92, v92, v9, v9
    v_fma_f32 v93, v93, v9, v9
    v_fma_f32 v94, v94, v9, v9
    v_fma_f32 v95, v95, v9, v9
    v_rcp_f32 v88, v88
    v_rcp_f32 v89, v89
    v_rcp_f32 v90, v90
    v_rcp_f32 v91, v91
    v_rcp_f32 v92, v92
    v_rcp_f32 v93, v93
    v_rcp_f32 v94, v94
    v_rcp_f32 v95, v95
    v_mul_f32 v72, v72, v88
    v_mul_f32 v73, v73, v89
    v_mul_f32 v74, v74, v90
    v_mul_f32 v75, v75, v91
    v_mul_f32 v76, v76, v92
    v_mul_f32 v77, v77, v93
    v_mul_f32 v78, v78, v94
    v_mul_f32 v79, v79, v95
    v_cvt_pk_bf16_f32 v64, v72, v73
    v_cvt_pk_bf16_f32 v65, v74, v75
    v_cvt_pk_bf16_f32 v66, v76, v77
    v_cvt_pk_bf16_f32 v67, v78, v79
    buffer_store_dwordx4 v[64:67], v3, s[16:19], s40 offen offset:3072 sc1
    s_waitcnt vmcnt(0)
    v_mov_b32 v8, s42
    v_mov_b32 v9, 1
    s_mov_b64 exec, 1
    ds_add_rtn_u32 v10, v8, v9
    s_waitcnt lgkmcnt(0)
    v_readfirstlane_b32 s56, v10
    s_nop 0
    s_cmp_lg_u32 s56, 3
    s_cbranch_scc1 km_arrC
    v_mov_b32 v8, 0
    s_mov_b32 s56, 1
    s_atomic_add s56, s[6:7], s41 glc
    s_waitcnt lgkmcnt(0)
    s_cmp_lg_u32 s56, 27
    s_cbranch_scc1 km_arrC
    buffer_store_dword v9, v8, s[16:19], s41 offen offset:128 sc1
km_arrC:
    s_mov_b64 exec, -1
    s_branch km_D
km_csb:
    v_mov_b32 v8, 163332
    s_mov_b32 s57, 0
km_spinR2:
    ds_read_b32 v9, v8
    s_waitcnt lgkmcnt(0)
    v_readfirstlane_b32 s56, v9
    s_nop 0
    s_cmp_ge_u32 s56, 10
    s_cbranch_scc1 km_spinR2_ok
    s_sleep 1
    s_add_u32 s57, s57, 1
    s_cmp_lt_u32 s57, 2097152
    s_cbranch_scc1 km_spinR2
km_spinR2_ok:
    v_mov_b32 v8, 163348
    s_mov_b32 s57, 0
km_spinW3:
    ds_read_b32 v9, v8
    s_waitcnt lgkmcnt(0)
    v_readfirstlane_b32 s56, v9
    s_nop 0
    s_cmp_ge_u32 s56, 4
    s_cbranch_scc1 km_spinW3_ok
    s_sleep 1
    s_add_u32 s57, s57, 1
    s_cmp_lt_u32 s57, 2097152
    s_cbranch_scc1 km_spinW3
km_spinW3_ok:
    s_cmp_lg_u32 s27, 0
    s_cbranch_scc1 km_csb_done
    s_cmp_ge_u32 s49, 7
    s_cbranch_scc1 km_csb_done
    s_lshl_b32 s32, s26, 5
    v_xor_b32 v12, s32, v12
    v_add_u32 v13, 65536, v12
    v_and_b32 v10, 1, v1
    v_lshlrev_b32 v10, 10, v10
    v_lshl_add_u32 v10, v4, 4, v10
    v_add_u32 v10, 156672, v10
    s_lshl_b32 s33, s50, 6
    v_add_u32 v11, s33, v10
    s_add_u32 s33, s33, 64
    s_and_b32 s33, s33, 1023
    ds_read_b128 v[32:35], v11 offset:0
    ds_read_b64_tr_b16 v[36:37], v12 offset:0
    ds_read_b64_tr_b16 v[38:39], v12 offset:512
    ds_read_b128 v[40:43], v11 offset:32
    ds_read_b64_tr_b16 v[44:45], v12 offset:2048
    ds_read_b64_tr_b16 v[46:47], v12 offset:2560
    v_add_u32 v11, s33, v10
    s_add_u32 s33, s33, 64
    s_and_b32 s33, s33, 1023
    ds_read_b128 v[48:51], v11 offset:0
    ds_read_b64_tr_b16 v[52:53], v12 offset:8192
    ds_read_b64_tr_b16 v[54:55], v12 offset:8704
    ds_read_b128 v[56:59], v11 offset:32
    ds_read_b64_tr_b16 v[60:61], v12 offset:10240
    ds_read_b64_tr_b16 v[62:63], v12 offset:10752
    v_add_u32 v11, s33, v10
    s_add_u32 s33, s33, 64
    s_and_b32 s33, s33, 1023
    ds_read_b128 v[64:67], v11 offset:0
    ds_read_b64_tr_b16 v[68:69], v12 offset:16384
    ds_read_b64_tr_b16 v[70:71], v12 offset:16896
    ds_read_b128 v[72:75], v11 offset:32
    ds_read_b64_tr_b16 v[76:77], v12 offset:18432
    ds_read_b64_tr_b16 v[78:79], v12 offset:18944
    v_add_u32 v11, s33, v10
    s_add_u32 s33, s33, 64
    s_and_b32 s33, s33, 1023
    ds_read_b128 v[80:83], v11 offset:0
    ds_read_b64_tr_b16 v[84:85], v12 offset:24576
    ds_read_b64_tr_b16 v[86:87], v12 offset:25088
    ds_read_b128 v[88:91], v11 offset:32
    ds_read_b64_tr_b16 v[92:93], v12 offset:26624
    ds_read_b64_tr_b16 v[94:95], v12 offset:27136
    s_waitcnt lgkmcnt(15)
    v_mfma_f32_32x32x16_bf16 v[16:31], v[32:35], v[36:39], 0
    s_waitcnt lgkmcnt(15)
    v_mfma_f32_32x32x16_bf16 v[16:31], v[40:43], v[44:47], v[16:31]
    s_waitcnt lgkmcnt(15)
    v_mfma_f32_32x32x16_bf16 v[16:31], v[48:51], v[52:55], v[16:31]
    s_waitcnt lgkmcnt(12)
    v_mfma_f32_32x32x16_bf16 v[16:31], v[56:59], v[60:63], v[16:31]
    s_waitcnt lgkmcnt(9)
    v_mfma_f32_32x32x16_bf16 v[16:31], v[64:67], v[68:71], v[16:31]
    s_waitcnt lgkmcnt(6)
    v_mfma_f32_32x32x16_bf16 v[16:31], v[72:75], v[76:79], v[16:31]
    s_waitcnt lgkmcnt(3)
    v_mfma_f32_32x32x16_bf16 v[16:31], v[80:83], v[84:87], v[16:31]
    s_waitcnt lgkmcnt(0)
    v_mfma_f32_32x32x16_bf16 v[16:31], v[88:91], v[92:95], v[16:31]
    v_add_u32 v11, s33, v10
    s_add_u32 s33, s33, 64
    s_and_b32 s33, s33, 1023
    ds_read_b128 v[32:35], v11 offset:0
    ds_read_b64_tr_b16 v[36:37], v12 offset:32768
    ds_read_b64_tr_b16 v[38:39], v12 offset:33280
    ds_read_b128 v[40:43], v11 offset:32
    ds_read_b64_tr_b16 v[44:45], v12 offset:34816
    ds_read_b64_tr_b16 v[46:47], v12 offset:35328
    v_add_u32 v11, s33, v10
    s_add_u32 s33, s33, 64
    s_and_b32 s33, s33, 1023
    ds_read_b128 v[48:51], v11 offset:0
    ds_read_b64_tr_b16 v[52:53], v12 offset:40960
    ds_read_b64_tr_b16 v[54:55], v12 offset:41472
    ds_read_b128 v[56:59], v11 offset:32
    ds_read_b64_tr_b16 v[60:61], v12 offset:43008
    ds_read_b64_tr_b16 v[62:63], v12 offset:43520
    v_add_u32 v11, s33, v10
    s_add_u32 s33, s33, 64
    s_and_b32 s33, s33, 1023
    ds_read_b128 v[64:67], v11 offset:0
    ds_read_b64_tr_b16 v[68:69], v12 offset:49152
    ds_read_b64_tr_b16 v[70:71], v12 offset:49664
    ds_read_b128 v[72:75], v11 offset:32
    ds_read_b64_tr_b16 v[76:77], v12 offset:51200
    ds_read_b64_tr_b16 v[78:79], v12 offset:51712
    v_add_u32 v11, s33, v10
    s_add_u32 s33, s33, 64
    s_and_b32 s33, s33, 1023
    ds_read_b128 v[80:83], v11 offset:0
    ds_read_b64_tr_b16 v[84:85], v12 offset:57344
    ds_read_b64_tr_b16 v[86:87], v12 offset:57856
    ds_read_b128 v[88:91], v11 offset:32
    ds_read_b64_tr_b16 v[92:93], v12 offset:59392
    ds_read_b64_tr_b16 v[94:95], v12 offset:59904
    s_waitcnt lgkmcnt(15)
    v_mfma_f32_32x32x16_bf16 v[16:31], v[32:35], v[36:39], v[16:31]
    s_waitcnt lgkmcnt(15)
    v_mfma_f32_32x32x16_bf16 v[16:31], v[40:43], v[44:47], v[16:31]
    s_waitcnt lgkmcnt(15)
    v_mfma_f32_32x32x16_bf16 v[16:31], v[48:51], v[52:55], v[16:31]
    s_waitcnt lgkmcnt(12)
    v_mfma_f32_32x32x16_bf16 v[16:31], v[56:59], v[60:63], v[16:31]
    s_waitcnt lgkmcnt(9)
    v_mfma_f32_32x32x16_bf16 v[16:31], v[64:67], v[68:71], v[16:31]
    s_waitcnt lgkmcnt(6)
    v_mfma_f32_32x32x16_bf16 v[16:31], v[72:75], v[76:79], v[16:31]
    s_waitcnt lgkmcnt(3)
    v_mfma_f32_32x32x16_bf16 v[16:31], v[80:83], v[84:87], v[16:31]
    s_waitcnt lgkmcnt(0)
    v_mfma_f32_32x32x16_bf16 v[16:31], v[88:91], v[92:95], v[16:31]
    v_add_u32 v11, s33, v10
    s_add_u32 s33, s33, 64
    s_and_b32 s33, s33, 1023
    ds_read_b128 v[32:35], v11 offset:0
    ds_read_b64_tr_b16 v[36:37], v13 offset:0
    ds_read_b64_tr_b16 v[38:39], v13 offset:512
    ds_read_b128 v[40:43], v11 offset:32
    ds_read_b64_tr_b16 v[44:45], v13 offset:2048
    ds_read_b64_tr_b16 v[46:47], v13 offset:2560
    v_add_u32 v11, s33, v10
    s_add_u32 s33, s33, 64
    s_and_b32 s33, s33, 1023
    ds_read_b128 v[48:51], v11 offset:0
    ds_read_b64_tr_b16 v[52:53], v13 offset:8192
    ds_read_b64_tr_b16 v[54:55], v13 offset:8704
    ds_read_b128 v[56:59], v11 offset:32
    ds_read_b64_tr_b16 v[60:61], v13 offset:10240
    ds_read_b64_tr_b16 v[62:63], v13 offset:10752
    v_add_u32 v11, s33, v10
    s_add_u32 s33, s33, 64
    s_and_b32 s33, s33, 1023
    ds_read_b128 v[64:67], v11 offset:0
    ds_read_b64_tr_b16 v[68:69], v13 offset:16384
    ds_read_b64_tr_b16 v[70:71], v13 offset:16896
    ds_read_b128 v[72:75], v11 offset:32
    ds_read_b64_tr_b16 v[76:77], v13 offset:18432
    ds_read_b64_tr_b16 v[78:79], v13 offset:18944
    v_add_u32 v11, s33, v10
    s_add_u32 s33, s33, 64
    s_and_b32 s33, s33, 1023
    ds_read_b128 v[80:83], v11 offset:0
    ds_read_b64_tr_b16 v[84:85], v13 offset:24576
    ds_read_b64_tr_b16 v[86:87], v13 offset:25088
    ds_read_b128 v[88:91], v11 offset:32
    ds_read_b64_tr_b16 v[92:93], v13 offset:26624
    ds_read_b64_tr_b16 v[94:95], v13 offset:27136
    s_waitcnt lgkmcnt(15)
    v_mfma_f32_32x32x16_bf16 v[16:31], v[32:35], v[36:39], v[16:31]
    s_waitcnt lgkmcnt(15)
    v_mfma_f32_32x32x16_bf16 v[16:31], v[40:43], v[44:47], v[16:31]
    s_waitcnt lgkmcnt(15)
    v_mfma_f32_32x32x16_bf16 v[16:31], v[48:51], v[52:55], v[16:31]
    s_waitcnt lgkmcnt(12)
    v_mfma_f32_32x32x16_bf16 v[16:31], v[56:59], v[60:63], v[16:31]
    s_waitcnt lgkmcnt(9)
    v_mfma_f32_32x32x16_bf16 v[16:31], v[64:67], v[68:71], v[16:31]
    s_waitcnt lgkmcnt(6)
    v_mfma_f32_32x32x16_bf16 v[16:31], v[72:75], v[76:79], v[16:31]
    s_waitcnt lgkmcnt(3)
    v_mfma_f32_32x32x16_bf16 v[16:31], v[80:83], v[84:87], v[16:31]
    s_waitcnt lgkmcnt(0)
    v_mfma_f32_32x32x16_bf16 v[16:31], v[88:91], v[92:95], v[16:31]
    v_add_u32 v11, s33, v10
    s_add_u32 s33, s33, 64
    s_and_b32 s33, s33, 1023
    ds_read_b128 v[32:35], v11 offset:0
    ds_read_b64_tr_b16 v[36:37], v13 offset:32768
    ds_read_b64_tr_b16 v[38:39], v13 offset:33280
    ds_read_b128 v[40:43], v11 offset:32
    ds_read_b64_tr_b16 v[44:45], v13 offset:34816
    ds_read_b64_tr_b16 v[46:47], v13 offset:35328
    v_add_u32 v11, s33, v10
    s_add_u32 s33, s33, 64
    s_and_b32 s33, s33, 1023
    ds_read_b128 v[48:51], v11 offset:0
    ds_read_b64_tr_b16 v[52:53], v13 offset:40960
    ds_read_b64_tr_b16 v[54:55], v13 offset:41472
    ds_read_b128 v[56:59], v11 offset:32
    ds_read_b64_tr_b16 v[60:61], v13 offset:43008
    ds_read_b64_tr_b16 v[62:63], v13 offset:43520
    v_add_u32 v11, s33, v10
    s_add_u32 s33, s33, 64
    s_and_b32 s33, s33, 1023
    ds_read_b128 v[64:67], v11 offset:0
    ds_read_b64_tr_b16 v[68:69], v13 offset:49152
    ds_read_b64_tr_b16 v[70:71], v13 offset:49664
    ds_read_b128 v[72:75], v11 offset:32
    ds_read_b64_tr_b16 v[76:77], v13 offset:51200
    ds_read_b64_tr_b16 v[78:79], v13 offset:51712
    v_add_u32 v11, s33, v10
    s_add_u32 s33, s33, 64
    s_and_b32 s33, s33, 1023
    ds_read_b128 v[80:83], v11 offset:0
    ds_read_b64_tr_b16 v[84:85], v13 offset:57344
    ds_read_b64_tr_b16 v[86:87], v13 offset:57856
    ds_read_b128 v[88:91], v11 offset:32
    ds_read_b64_tr_b16 v[92:93], v13 offset:59392
    ds_read_b64_tr_b16 v[94:95], v13 offset:59904
    s_waitcnt lgkmcnt(15)
    v_mfma_f32_32x32x16_bf16 v[16:31], v[32:35], v[36:39], v[16:31]
    s_waitcnt lgkmcnt(15)
    v_mfma_f32_32x32x16_bf16 v[16:31], v[40:43], v[44:47], v[16:31]
    s_waitcnt lgkmcnt(15)
    v_mfma_f32_32x32x16_bf16 v[16:31], v[48:51], v[52:55], v[16:31]
    s_waitcnt lgkmcnt(12)
    v_mfma_f32_32x32x16_bf16 v[16:31], v[56:59], v[60:63], v[16:31]
    s_waitcnt lgkmcnt(9)
    v_mfma_f32_32x32x16_bf16 v[16:31], v[64:67], v[68:71], v[16:31]
    s_waitcnt lgkmcnt(6)
    v_mfma_f32_32x32x16_bf16 v[16:31], v[72:75], v[76:79], v[16:31]
    s_waitcnt lgkmcnt(3)
    v_mfma_f32_32x32x16_bf16 v[16:31], v[80:83], v[84:87], v[16:31]
    s_waitcnt lgkmcnt(0)
    v_mfma_f32_32x32x16_bf16 v[16:31], v[88:91], v[92:95], v[16:31]
    s_nop 7
    s_nop 3
    v_cvt_pk_bf16_f32 v100, v16, v16
    v_and_b32 v104, s46, v100
    v_sub_f32 v104, v16, v104
    v_cvt_pk_bf16_f32 v101, v104, v104
    v_cvt_pk_bf16_f32 v102, v17, v17
    v_and_b32 v104, s46, v102
    v_sub_f32 v104, v17, v104
    v_cvt_pk_bf16_f32 v103, v104, v104
    s_lshl_b32 s32, s26, 9
    s_add_u32 s35, s35, s32
    s_mov_b32 exec_hi, 0
    buffer_store_dwordx4 v[100:103], v7, s[16:19], s35 offen sc1
    s_mov_b64 exec, -1
    s_waitcnt vmcnt(0)
    v_mov_b32 v8, 163356
    v_mov_b32 v9, 1
    s_mov_b64 exec, 1
    ds_add_rtn_u32 v10, v8, v9
    s_waitcnt lgkmcnt(0)
    v_readfirstlane_b32 s56, v10
    s_nop 0
    s_cmp_lg_u32 s56, 3
    s_cbranch_scc1 km_arrS
    v_mov_b32 v8, 0
    buffer_store_dword v9, v8, s[16:19], s34 offen sc1
km_arrS:
    s_mov_b64 exec, -1
km_csb_done:
    s_mov_b64 exec, 1
    ds_add_u32 v0, v2 offset:0
    s_mov_b64 exec, -1
    s_mov_b64 exec, 1
    ds_add_u32 v0, v2 offset:4
    s_mov_b64 exec, -1
    s_mov_b64 exec, 1
    ds_add_u32 v0, v2 offset:8
    s_mov_b64 exec, -1
    s_mov_b64 exec, 1
    ds_add_u32 v0, v2 offset:12
    s_mov_b64 exec, -1
km_D:
    s_cmp_eq_u32 s27, 0
    s_cbranch_scc1 km_d_pa
    s_setprio 0
    s_branch km_d_pb
km_d_pa:
    s_setprio 0
km_d_pb:
    s_and_b32 s51, s21, 3
    s_lshr_b32 s52, s21, 2
    s_lshl_b32 s53, s20, 2
    s_add_u32 s53, s53, s51
    s_lshl_b32 s54, s51, 1
    s_add_u32 s54, s54, s52
    s_and_b32 s54, s54, 7
    s_cmp_eq_u32 s54, 7
    s_cselect_b32 s54, 3, s54
    s_lshl_b32 s29, s27, 5
    s_add_u32 s53, s53, s29
    v_bfe_u32 v12, v1, 2, 2
    v_lshl_add_u32 v12, v4, 3, v12
    v_lshlrev_b32 v12, 7, v12
    v_bfe_u32 v13, v1, 4, 1
    v_lshl_add_u32 v12, v13, 5, v12
    v_and_b32 v13, 1, v1
    v_lshl_add_u32 v12, v13, 4, v12
    v_bfe_u32 v13, v1, 1, 1
    v_lshl_add_u32 v12, v13, 3, v12
    v_bfe_u32 v13, v1, 3, 1
    v_lshl_add_u32 v12, v13, 6, v12
    s_lshl_b32 s29, s26, 5
    v_xor_b32 v12, s29, v12
    s_lshl_b32 s29, s26, 13
    v_add_u32 v12, s29, v12
    v_xor_b32 v13, 64, v12
    v_add_u32 v14, 65536, v12
    v_add_u32 v15, 65536, v13
    s_mul_i32 s30, s53, 114688
    s_mul_i32 s31, s26, 28672
    s_add_u32 s30, s30, s31
    s_add_u32 s30, s30, 0x700000
    s_add_u32 s31, s54, 0
    s_sub_u32 s32, s31, 7
    s_cmp_ge_u32 s31, 7
    s_cselect_b32 s31, s32, s31
    s_lshl_b32 s31, s31, 12
    s_add_u32 s33, s31, s30
    s_add_u32 s31, s54, 1
    s_sub_u32 s32, s31, 7
    s_cmp_ge_u32 s31, 7
    s_cselect_b32 s31, s32, s31
    s_lshl_b32 s31, s31, 12
    s_add_u32 s34, s31, s30
    s_add_u32 s31, s54, 2
    s_sub_u32 s32, s31, 7
    s_cmp_ge_u32 s31, 7
    s_cselect_b32 s31, s32, s31
    s_lshl_b32 s31, s31, 12
    s_add_u32 s35, s31, s30
    s_add_u32 s31, s54, 3
    s_sub_u32 s32, s31, 7
    s_cmp_ge_u32 s31, 7
    s_cselect_b32 s31, s32, s31
    s_lshl_b32 s31, s31, 12
    s_add_u32 s36, s31, s30
    s_add_u32 s31, s54, 4
    s_sub_u32 s32, s31, 7
    s_cmp_ge_u32 s31, 7
    s_cselect_b32 s31, s32, s31
    s_lshl_b32 s31, s31, 12
    s_add_u32 s37, s31, s30
    s_add_u32 s31, s54, 5
    s_sub_u32 s32, s31, 7
    s_cmp_ge_u32 s31, 7
    s_cselect_b32 s31, s32, s31
    s_lshl_b32 s31, s31, 12
    s_add_u32 s38, s31, s30
    s_add_u32 s31, s54, 6
    s_sub_u32 s32, s31, 7
    s_cmp_ge_u32 s31, 7
    s_cselect_b32 s31, s32, s31
    s_lshl_b32 s31, s31, 12
    s_add_u32 s39, s31, s30
    s_lshr_b32 s32, s53, 2
    s_lshl_b32 s32, s32, 8
    s_add_u32 s32, s32, 0x10880
    s_lshl_b32 s44, s52, 3
    s_lshl_b32 s45, s26, 1
    s_add_u32 s44, s44, s45
    v_add_u32 v11, s44, v4
    s_and_b32 s47, s53, 31
    v_lshlrev_b32 v5, 6, v6
    v_add_u32 v5, s47, v5
    v_subrev_u32 v8, 992, v5
    v_cmp_lt_u32 vcc, 15, v6
    s_cmp_eq_u32 s47, 0
    s_cselect_b64 vcc, vcc, 0
    v_cndmask_b32 v5, v5, v8, vcc
    s_cmp_ge_u32 s53, 32
    s_cselect_b64 s[58:59], -1, 0
    v_sub_u32 v8, 2048, v5
    v_cmp_eq_u32 vcc, 0, v5
    v_mov_b32 v9, 1024
    s_nop 0
    v_cndmask_b32 v8, v8, v9, vcc
    v_cndmask_b32 v5, v5, v8, s[58:59]
    v_lshlrev_b32 v5, 10, v5
    v_lshl_add_u32 v5, v11, 4, v5
    s_lshl_b32 s45, s53, 15
    s_add_u32 s45, s45, 0x300000
    s_lshl_b32 s29, s26, 2
    s_add_u32 s29, s29, 163392
    v_mov_b32 v0, s29
    s_lshl_b32 s29, s27, 2
    s_add_u32 s29, s29, 163368
    v_mov_b32 v7, s29
    s_lshl_b32 s29, s27, 5
    v_add_u32 v10, s29, v0
    s_mov_b32 s40, s8
    s_mov_b32 s41, s9
    s_mov_b32 s42, 0x200000
    s_mov_b32 s43, 0x20000
    s_cmp_eq_u32 s27, 0
    s_cselect_b32 s60, 0, 2048
    s_add_u32 s60, s60, 6144
    s_cmp_eq_u32 s27, 0
    s_cselect_b32 s61, 32768, 0
    s_add_u32 s61, s61, 98304
    s_xor_b32 s29, s26, 0
    s_mul_i32 s29, s29, s60
    s_add_u32 s48, s29, s61
    s_xor_b32 s29, s26, 1
    s_mul_i32 s29, s29, s60
    s_add_u32 s49, s29, s61
    s_xor_b32 s29, s26, 2
    s_mul_i32 s29, s29, s60
    s_add_u32 s50, s29, s61
    s_xor_b32 s29, s26, 3
    s_mul_i32 s29, s29, s60
    s_add_u32 s51, s29, s61
    s_mov_b32 s31, 3
    s_mov_b32 s57, 0
km_spinD1:
    ds_read_b32 v9, v0 offset:0
    s_waitcnt lgkmcnt(0)
    v_readfirstlane_b32 s56, v9
    s_nop 0
    s_cmp_ge_u32 s56, s31
    s_cbranch_scc1 km_spinD1_ok
    s_sleep 2
    s_add_u32 s57, s57, 1
    s_cmp_lt_u32 s57, 2097152
    s_cbranch_scc1 km_spinD1
km_spinD1_ok:
    ds_read_b64_tr_b16 v[48:49], v12 offset:0
    ds_read_b64_tr_b16 v[50:51], v12 offset:512
    ds_read_b64_tr_b16 v[52:53], v13 offset:0
    ds_read_b64_tr_b16 v[54:55], v13 offset:512
    ds_read_b64_tr_b16 v[56:57], v12 offset:2048
    ds_read_b64_tr_b16 v[58:59], v12 offset:2560
    ds_read_b64_tr_b16 v[60:61], v13 offset:2048
    ds_read_b64_tr_b16 v[62:63], v13 offset:2560
    ds_read_b64_tr_b16 v[64:65], v12 offset:4096
    ds_read_b64_tr_b16 v[66:67], v12 offset:4608
    ds_read_b64_tr_b16 v[68:69], v13 offset:4096
    ds_read_b64_tr_b16 v[70:71], v13 offset:4608
    ds_read_b64_tr_b16 v[72:73], v12 offset:6144
    ds_read_b64_tr_b16 v[74:75], v12 offset:6656
    ds_read_b64_tr_b16 v[76:77], v13 offset:6144
    ds_read_b64_tr_b16 v[78:79], v13 offset:6656
    ds_read_b64_tr_b16 v[80:81], v12 offset:32768
    ds_read_b64_tr_b16 v[82:83], v12 offset:33280
    ds_read_b64_tr_b16 v[84:85], v13 offset:32768
    ds_read_b64_tr_b16 v[86:87], v13 offset:33280
    ds_read_b64_tr_b16 v[88:89], v12 offset:34816
    ds_read_b64_tr_b16 v[90:91], v12 offset:35328
    ds_read_b64_tr_b16 v[92:93], v13 offset:34816
    ds_read_b64_tr_b16 v[94:95], v13 offset:35328
    ds_read_b64_tr_b16 v[96:97], v12 offset:36864
    ds_read_b64_tr_b16 v[98:99], v12 offset:37376
    ds_read_b64_tr_b16 v[100:101], v13 offset:36864
    ds_read_b64_tr_b16 v[102:103], v13 offset:37376
    ds_read_b64_tr_b16 v[104:105], v12 offset:38912
    ds_read_b64_tr_b16 v[106:107], v12 offset:39424
    ds_read_b64_tr_b16 v[108:109], v13 offset:38912
    ds_read_b64_tr_b16 v[110:111], v13 offset:39424
    ds_read_b64_tr_b16 v[112:113], v14 offset:0
    ds_read_b64_tr_b16 v[114:115], v14 offset:512
    ds_read_b64_tr_b16 v[116:117], v15 offset:0
    ds_read_b64_tr_b16 v[118:119], v15 offset:512
    ds_read_b64_tr_b16 v[120:121], v14 offset:2048
    ds_read_b64_tr_b16 v[122:123], v14 offset:2560
    ds_read_b64_tr_b16 v[124:125], v15 offset:2048
    ds_read_b64_tr_b16 v[126:127], v15 offset:2560
    ds_read_b64_tr_b16 v[128:129], v14 offset:4096
    ds_read_b64_tr_b16 v[130:131], v14 offset:4608
    ds_read_b64_tr_b16 v[132:133], v15 offset:4096
    ds_read_b64_tr_b16 v[134:135], v15 offset:4608
    ds_read_b64_tr_b16 v[136:137], v14 offset:6144
    ds_read_b64_tr_b16 v[138:139], v14 offset:6656
    ds_read_b64_tr_b16 v[140:141], v15 offset:6144
    ds_read_b64_tr_b16 v[142:143], v15 offset:6656
    s_waitcnt lgkmcnt(0)
    v_mov_b32 v9, 3
    s_mov_b64 exec, 1
    ds_add_u32 v10, v9 offset:16
    s_mov_b64 exec, -1
    s_cmp_lg_u32 s26, 0
    s_cbranch_scc1 km_d_w
    v_lshlrev_b32 v8, 2, v1
    s_mov_b32 s57, 0
    s_mov_b32 exec_lo, 0x1
    s_mov_b32 exec_hi, 0
km_pollC:
    buffer_load_dword v9, v8, s[16:19], s32 offen sc1
    s_waitcnt vmcnt(0)
    v_cmp_lt_u32 vcc, 0, v9
    s_nop 0
    s_cmp_eq_u32 vcc_lo, 0x1
    s_cbranch_scc1 km_pollC_ok
    s_sleep 2
    s_add_u32 s57, s57, 1
    s_cmp_lt_u32 s57, 131072
    s_cbranch_scc1 km_pollC
km_pollC_ok:
    s_mov_b64 exec, -1
    s_mov_b64 exec, 1
    ds_add_u32 v7, v2 offset:0
    s_mov_b64 exec, -1
    s_branch km_d_go
km_d_w:
    s_mov_b32 s57, 0
km_spinH:
    ds_read_b32 v9, v7 offset:0
    s_waitcnt lgkmcnt(0)
    v_readfirstlane_b32 s56, v9
    s_nop 0
    s_cmp_ge_u32 s56, 1
    s_cbranch_scc1 km_spinH_ok
    s_sleep 1
    s_add_u32 s57, s57, 1
    s_cmp_lt_u32 s57, 2097152
    s_cbranch_scc1 km_spinH
km_spinH_ok:
km_d_go:
    s_cmp_eq_u32 s27, 1
    s_cbranch_scc1 km_dB
    buffer_load_dwordx4 v[144:147], v3, s[16:19], s33 offen offset:0 sc1
    buffer_load_dwordx4 v[148:151], v3, s[16:19], s33 offen offset:1024 sc1
    buffer_load_dwordx4 v[152:155], v3, s[16:19], s33 offen offset:2048 sc1
    buffer_load_dwordx4 v[156:159], v3, s[16:19], s33 offen offset:3072 sc1
    buffer_load_dwordx4 v[160:163], v3, s[16:19], s34 offen offset:0 sc1
    s_waitcnt vmcnt(4)
    v_mfma_f32_32x32x16_bf16 v[16:31], v[48:51], v[144:147], 0
    v_mfma_f32_32x32x16_bf16 v[32:47], v[52:55], v[144:147], 0
    s_waitcnt vmcnt(3)
    v_mfma_f32_32x32x16_bf16 v[16:31], v[56:59], v[148:151], v[16:31]
    buffer_load_dwordx4 v[48:51], v3, s[16:19], s34 offen offset:1024 sc1
    v_mfma_f32_32x32x16_bf16 v[32:47], v[60:63], v[148:151], v[32:47]
    buffer_load_dwordx4 v[52:55], v3, s[16:19], s34 offen offset:2048 sc1
    s_waitcnt vmcnt(4)
    v_mfma_f32_32x32x16_bf16 v[16:31], v[64:67], v[152:155], v[16:31]
    buffer_load_dwordx4 v[56:59], v3, s[16:19], s34 offen offset:3072 sc1
    v_mfma_f32_32x32x16_bf16 v[32:47], v[68:71], v[152:155], v[32:47]
    buffer_load_dwordx4 v[60:63], v3, s[16:19], s35 offen offset:0 sc1
    s_waitcnt vmcnt(5)
    v_mfma_f32_32x32x16_bf16 v[16:31], v[72:75], v[156:159], v[16:31]
    buffer_load_dwordx4 v[64:67], v3, s[16:19], s35 offen offset:1024 sc1
    v_mfma_f32_32x32x16_bf16 v[32:47], v[76:79], v[156:159], v[32:47]
    buffer_load_dwordx4 v[68:71], v3, s[16:19], s35 offen offset:2048 sc1
    s_waitcnt vmcnt(6)
    v_mfma_f32_32x32x16_bf16 v[16:31], v[80:83], v[160:163], v[16:31]
    buffer_load_dwordx4 v[72:75], v3, s[16:19], s35 offen offset:3072 sc1
    v_mfma_f32_32x32x16_bf16 v[32:47], v[84:87], v[160:163], v[32:47]
    buffer_load_dwordx4 v[76:79], v3, s[16:19], s36 offen offset:0 sc1
    s_waitcnt vmcnt(7)
    v_mfma_f32_32x32x16_bf16 v[16:31], v[88:91], v[48:51], v[16:31]
    buffer_load_dwordx4 v[80:83], v3, s[16:19], s36 offen offset:1024 sc1
    v_mfma_f32_32x32x16_bf16 v[32:47], v[92:95], v[48:51], v[32:47]
    buffer_load_dwordx4 v[84:87], v3, s[16:19], s36 offen offset:2048 sc1
    s_waitcnt vmcnt(8)
    v_mfma_f32_32x32x16_bf16 v[16:31], v[96:99], v[52:55], v[16:31]
    buffer_load_dwordx4 v[88:91], v3, s[16:19], s36 offen offset:3072 sc1
    v_mfma_f32_32x32x16_bf16 v[32:47], v[100:103], v[52:55], v[32:47]
    buffer_load_dwordx4 v[92:95], v3, s[16:19], s37 offen offset:0 sc1
    v_lshlrev_b32 v8, 4, v11
    v_add_u32 v8, 158720, v8
    ds_read_b128 v[152:155], v8
    v_sub_u32 v8, 95, v11
    v_cmp_gt_u32 vcc, 32, v11
    s_nop 1
    v_cndmask_b32 v8, v8, v11, vcc
    s_waitcnt vmcnt(9)
    v_mfma_f32_32x32x16_bf16 v[16:31], v[104:107], v[56:59], v[16:31]
    v_mfma_f32_32x32x16_bf16 v[32:47], v[108:111], v[56:59], v[32:47]
    buffer_load_dwordx4 v[48:51], v3, s[16:19], s37 offen offset:1024 sc1
    v_lshlrev_b32 v8, 9, v8
    v_lshl_add_u32 v156, v6, 4, v8
    v_sub_u32 v8, 64, v11
    v_and_b32 v8, 31, v8
    v_add_u32 v8, 32, v8
    v_lshlrev_b32 v8, 9, v8
    ds_read_b32 v166, v0
    s_waitcnt vmcnt(9)
    v_mfma_f32_32x32x16_bf16 v[16:31], v[112:115], v[60:63], v[16:31]
    v_mfma_f32_32x32x16_bf16 v[32:47], v[116:119], v[60:63], v[32:47]
    buffer_load_dwordx4 v[96:99], v3, s[16:19], s37 offen offset:2048 sc1
    v_lshl_add_u32 v157, v6, 4, v8
    v_add_u32 v160, s48, v3
    v_add_u32 v161, s49, v3
    v_add_u32 v162, s50, v3
    v_add_u32 v163, s51, v3
    v_and_b32 v164, 3, v1
    s_waitcnt lgkmcnt(0)
    v_readfirstlane_b32 s56, v166
    s_add_u32 s31, s31, 1
    s_cmp_ge_u32 s56, s31
    s_cbranch_scc1 km_fuA9_ok
    s_mov_b32 s57, 0
km_fuA9:
    ds_read_b32 v9, v0 offset:0
    s_waitcnt lgkmcnt(0)
    v_readfirstlane_b32 s56, v9
    s_nop 0
    s_cmp_ge_u32 s56, s31
    s_cbranch_scc1 km_fuA9_ok
    s_sleep 1
    s_add_u32 s57, s57, 1
    s_cmp_lt_u32 s57, 2097152
    s_cbranch_scc1 km_fuA9
km_fuA9_ok:
    ds_read_b64_tr_b16 v[100:101], v14 offset:32768
    ds_read_b64_tr_b16 v[102:103], v14 offset:33280
    ds_read_b64_tr_b16 v[52:53], v15 offset:32768
    ds_read_b64_tr_b16 v[54:55], v15 offset:33280
    s_waitcnt vmcnt(9)
    v_mfma_f32_32x32x16_bf16 v[16:31], v[120:123], v[64:67], v[16:31]
    v_mfma_f32_32x32x16_bf16 v[32:47], v[124:127], v[64:67], v[32:47]
    buffer_load_dwordx4 v[104:107], v3, s[16:19], s37 offen offset:3072 sc1
    v_lshlrev_b32 v164, 2, v164
    v_bfe_u32 v8, v1, 2, 1
    v_lshl_add_u32 v164, v8, 5, v164
    v_add_u32 v164, 163408, v164
    ds_read_b64_tr_b16 v[108:109], v14 offset:34816
    ds_read_b64_tr_b16 v[110:111], v14 offset:35328
    ds_read_b64_tr_b16 v[56:57], v15 offset:34816
    ds_read_b64_tr_b16 v[58:59], v15 offset:35328
    s_waitcnt vmcnt(9)
    v_mfma_f32_32x32x16_bf16 v[16:31], v[128:131], v[68:71], v[16:31]
    v_mfma_f32_32x32x16_bf16 v[32:47], v[132:135], v[68:71], v[32:47]
    buffer_load_dwordx4 v[112:115], v3, s[16:19], s38 offen offset:0 sc1
    ds_read_b64_tr_b16 v[116:117], v14 offset:36864
    ds_read_b64_tr_b16 v[118:119], v14 offset:37376
    ds_read_b64_tr_b16 v[60:61], v15 offset:36864
    ds_read_b64_tr_b16 v[62:63], v15 offset:37376
    s_waitcnt vmcnt(9)
    v_mfma_f32_32x32x16_bf16 v[16:31], v[136:139], v[72:75], v[16:31]
    v_mfma_f32_32x32x16_bf16 v[32:47], v[140:143], v[72:75], v[32:47]
    buffer_load_dwordx4 v[120:123], v3, s[16:19], s38 offen offset:1024 sc1
    ds_read_b32 v166, v0
    ds_read_b64_tr_b16 v[124:125], v14 offset:38912
    ds_read_b64_tr_b16 v[126:127], v14 offset:39424
    ds_read_b64_tr_b16 v[64:65], v15 offset:38912
    ds_read_b64_tr_b16 v[66:67], v15 offset:39424
    s_waitcnt vmcnt(9)
    s_waitcnt lgkmcnt(13)
    v_mfma_f32_32x32x16_bf16 v[16:31], v[100:103], v[76:79], v[16:31]
    v_mfma_f32_32x32x16_bf16 v[32:47], v[52:55], v[76:79], v[32:47]
    buffer_load_dwordx4 v[128:131], v3, s[16:19], s38 offen offset:2048 sc1
    s_waitcnt lgkmcnt(4)
    v_readfirstlane_b32 s56, v166
    s_add_u32 s31, s31, 1
    s_cmp_ge_u32 s56, s31
    s_cbranch_scc1 km_fuA13_ok
    s_mov_b32 s57, 0
km_fuA13:
    ds_read_b32 v9, v0 offset:0
    s_waitcnt lgkmcnt(0)
    v_readfirstlane_b32 s56, v9
    s_nop 0
    s_cmp_ge_u32 s56, s31
    s_cbranch_scc1 km_fuA13_ok
    s_sleep 1
    s_add_u32 s57, s57, 1
    s_cmp_lt_u32 s57, 2097152
    s_cbranch_scc1 km_fuA13
km_fuA13_ok:
    ds_read_b64_tr_b16 v[132:133], v12 offset:0
    ds_read_b64_tr_b16 v[134:135], v12 offset:512
    ds_read_b64_tr_b16 v[68:69], v13 offset:0
    ds_read_b64_tr_b16 v[70:71], v13 offset:512
    s_waitcnt vmcnt(9)
    s_waitcnt lgkmcnt(13)
    v_mfma_f32_32x32x16_bf16 v[16:31], v[108:111], v[80:83], v[16:31]
    v_mfma_f32_32x32x16_bf16 v[32:47], v[56:59], v[80:83], v[32:47]
    buffer_load_dwordx4 v[136:139], v3, s[16:19], s38 offen offset:3072 sc1
    ds_read_b64_tr_b16 v[140:141], v12 offset:2048
    ds_read_b64_tr_b16 v[142:143], v12 offset:2560
    ds_read_b64_tr_b16 v[72:73], v13 offset:2048
    ds_read_b64_tr_b16 v[74:75], v13 offset:2560
    s_waitcnt vmcnt(9)
    s_waitcnt lgkmcnt(13)
    v_mfma_f32_32x32x16_bf16 v[16:31], v[116:119], v[84:87], v[16:31]
    v_mfma_f32_32x32x16_bf16 v[32:47], v[60:63], v[84:87], v[32:47]
    buffer_load_dwordx4 v[100:103], v3, s[16:19], s39 offen offset:0 sc1
    ds_read_b64_tr_b16 v[52:53], v12 offset:4096
    ds_read_b64_tr_b16 v[54:55], v12 offset:4608
    ds_read_b64_tr_b16 v[76:77], v13 offset:4096
    ds_read_b64_tr_b16 v[78:79], v13 offset:4608
    s_waitcnt vmcnt(9)
    s_waitcnt lgkmcnt(12)
    v_mfma_f32_32x32x16_bf16 v[16:31], v[124:127], v[88:91], v[16:31]
    v_mfma_f32_32x32x16_bf16 v[32:47], v[64:67], v[88:91], v[32:47]
    buffer_load_dwordx4 v[108:111], v3, s[16:19], s39 offen offset:1024 sc1
    s_mov_b64 exec, 1
    ds_add_u32 v10, v2 offset:16
    s_mov_b64 exec, -1
    ds_read_b32 v166, v0
    ds_read_b64_tr_b16 v[56:57], v12 offset:6144
    ds_read_b64_tr_b16 v[58:59], v12 offset:6656
    ds_read_b64_tr_b16 v[80:81], v13 offset:6144
    ds_read_b64_tr_b16 v[82:83], v13 offset:6656
    s_waitcnt vmcnt(9)
    s_waitcnt lgkmcnt(14)
    v_mfma_f32_32x32x16_bf16 v[16:31], v[132:135], v[92:95], v[16:31]
    v_mfma_f32_32x32x16_bf16 v[32:47], v[68:71], v[92:95], v[32:47]
    buffer_load_dwordx4 v[116:119], v3, s[16:19], s39 offen offset:2048 sc1
    s_waitcnt lgkmcnt(4)
    v_readfirstlane_b32 s56, v166
    s_add_u32 s31, s31, 1
    s_cmp_ge_u32 s56, s31
    s_cbranch_scc1 km_fuA17_ok
    s_mov_b32 s57, 0
km_fuA17:
    ds_read_b32 v9, v0 offset:0
    s_waitcnt lgkmcnt(0)
    v_readfirstlane_b32 s56, v9
    s_nop 0
    s_cmp_ge_u32 s56, s31
    s_cbranch_scc1 km_fuA17_ok
    s_sleep 1
    s_add_u32 s57, s57, 1
    s_cmp_lt_u32 s57, 2097152
    s_cbranch_scc1 km_fuA17
km_fuA17_ok:
    ds_read_b64_tr_b16 v[60:61], v12 offset:32768
    ds_read_b64_tr_b16 v[62:63], v12 offset:33280
    ds_read_b64_tr_b16 v[84:85], v13 offset:32768
    ds_read_b64_tr_b16 v[86:87], v13 offset:33280
    s_waitcnt vmcnt(9)
    s_waitcnt lgkmcnt(14)
    v_mfma_f32_32x32x16_bf16 v[16:31], v[140:143], v[48:51], v[16:31]
    v_mfma_f32_32x32x16_bf16 v[32:47], v[72:75], v[48:51], v[32:47]
    buffer_load_dwordx4 v[124:127], v3, s[16:19], s39 offen offset:3072 sc1
    buffer_load_dwordx4 v[144:147], v156, s[16:19], s45 offen sc1
    buffer_load_ushort v148, v157, s[16:19], s45 offen sc1
    ds_read_b64_tr_b16 v[64:65], v12 offset:34816
    ds_read_b64_tr_b16 v[66:67], v12 offset:35328
    ds_read_b64_tr_b16 v[88:89], v13 offset:34816
    ds_read_b64_tr_b16 v[90:91], v13 offset:35328
    s_waitcnt vmcnt(11)
    s_waitcnt lgkmcnt(14)
    v_mfma_f32_32x32x16_bf16 v[16:31], v[52:55], v[96:99], v[16:31]
    v_mfma_f32_32x32x16_bf16 v[32:47], v[76:79], v[96:99], v[32:47]
    ds_read_b64_tr_b16 v[132:133], v12 offset:36864
    ds_read_b64_tr_b16 v[134:135], v12 offset:37376
    ds_read_b64_tr_b16 v[68:69], v13 offset:36864
    ds_read_b64_tr_b16 v[70:71], v13 offset:37376
    s_waitcnt vmcnt(10)
    s_waitcnt lgkmcnt(12)
    v_mfma_f32_32x32x16_bf16 v[16:31], v[56:59], v[104:107], v[16:31]
    v_mfma_f32_32x32x16_bf16 v[32:47], v[80:83], v[104:107], v[32:47]
    ds_read_b32 v166, v0
    ds_read_b64_tr_b16 v[92:93], v12 offset:38912
    ds_read_b64_tr_b16 v[94:95], v12 offset:39424
    ds_read_b64_tr_b16 v[140:141], v13 offset:38912
    ds_read_b64_tr_b16 v[142:143], v13 offset:39424
    s_waitcnt vmcnt(9)
    s_waitcnt lgkmcnt(13)
    v_mfma_f32_32x32x16_bf16 v[16:31], v[60:63], v[112:115], v[16:31]
    v_mfma_f32_32x32x16_bf16 v[32:47], v[84:87], v[112:115], v[32:47]
    s_waitcnt lgkmcnt(4)
    v_readfirstlane_b32 s56, v166
    s_add_u32 s31, s31, 1
    s_cmp_ge_u32 s56, s31
    s_cbranch_scc1 km_fuA21_ok
    s_mov_b32 s57, 0
km_fuA21:
    ds_read_b32 v9, v0 offset:0
    s_waitcnt lgkmcnt(0)
    v_readfirstlane_b32 s56, v9
    s_nop 0
    s_cmp_ge_u32 s56, s31
    s_cbranch_scc1 km_fuA21_ok
    s_sleep 1
    s_add_u32 s57, s57, 1
    s_cmp_lt_u32 s57, 2097152
    s_cbranch_scc1 km_fuA21
km_fuA21_ok:
    ds_read_b64_tr_b16 v[72:73], v14 offset:0
    ds_read_b64_tr_b16 v[74:75], v14 offset:512
    ds_read_b64_tr_b16 v[48:49], v15 offset:0
    ds_read_b64_tr_b16 v[50:51], v15 offset:512
    s_waitcnt vmcnt(8)
    s_waitcnt lgkmcnt(13)
    v_mfma_f32_32x32x16_bf16 v[16:31], v[64:67], v[120:123], v[16:31]
    v_mfma_f32_32x32x16_bf16 v[32:47], v[88:91], v[120:123], v[32:47]
    ds_read_b64_tr_b16 v[52:53], v14 offset:2048
    ds_read_b64_tr_b16 v[54:55], v14 offset:2560
    ds_read_b64_tr_b16 v[76:77], v15 offset:2048
    ds_read_b64_tr_b16 v[78:79], v15 offset:2560
    s_waitcnt vmcnt(7)
    s_waitcnt lgkmcnt(13)
    v_mfma_f32_32x32x16_bf16 v[16:31], v[132:135], v[128:131], v[16:31]
    v_mfma_f32_32x32x16_bf16 v[32:47], v[68:71], v[128:131], v[32:47]
    ds_read_b64_tr_b16 v[96:97], v14 offset:4096
    ds_read_b64_tr_b16 v[98:99], v14 offset:4608
    ds_read_b64_tr_b16 v[56:57], v15 offset:4096
    ds_read_b64_tr_b16 v[58:59], v15 offset:4608
    s_waitcnt vmcnt(6)
    s_waitcnt lgkmcnt(12)
    v_mfma_f32_32x32x16_bf16 v[16:31], v[92:95], v[136:139], v[16:31]
    v_mfma_f32_32x32x16_bf16 v[32:47], v[140:143], v[136:139], v[32:47]
    ds_read_b64_tr_b16 v[80:81], v14 offset:6144
    ds_read_b64_tr_b16 v[82:83], v14 offset:6656
    ds_read_b64_tr_b16 v[104:105], v15 offset:6144
    ds_read_b64_tr_b16 v[106:107], v15 offset:6656
    s_waitcnt vmcnt(5)
    s_waitcnt lgkmcnt(12)
    v_mfma_f32_32x32x16_bf16 v[16:31], v[72:75], v[100:103], v[16:31]
    v_mfma_f32_32x32x16_bf16 v[32:47], v[48:51], v[100:103], v[32:47]
    ds_read_b32 v165, v164
    s_waitcnt vmcnt(4)
    s_waitcnt lgkmcnt(9)
    v_mfma_f32_32x32x16_bf16 v[16:31], v[52:55], v[108:111], v[16:31]
    v_mfma_f32_32x32x16_bf16 v[32:47], v[76:79], v[108:111], v[32:47]
    s_waitcnt vmcnt(3)
    s_waitcnt lgkmcnt(5)
    v_mfma_f32_32x32x16_bf16 v[16:31], v[96:99], v[116:119], v[16:31]
    v_mfma_f32_32x32x16_bf16 v[32:47], v[56:59], v[116:119], v[32:47]
    s_waitcnt vmcnt(2)
    s_waitcnt lgkmcnt(1)
    v_mfma_f32_32x32x16_bf16 v[16:31], v[80:83], v[124:127], v[16:31]
    v_mfma_f32_32x32x16_bf16 v[32:47], v[104:107], v[124:127], v[32:47]
    s_branch km_djoin
km_dB:
    buffer_load_dwordx4 v[144:147], v3, s[16:19], s33 offen offset:0 sc1
    buffer_load_dwordx4 v[148:151], v3, s[16:19], s33 offen offset:1024 sc1
    buffer_load_dwordx4 v[152:155], v3, s[16:19], s33 offen offset:2048 sc1
    buffer_load_dwordx4 v[156:159], v3, s[16:19], s33 offen offset:3072 sc1
    buffer_load_dwordx4 v[160:163], v3, s[16:19], s34 offen offset:0 sc1
    s_waitcnt vmcnt(4)
    v_mfma_f32_32x32x16_bf16 v[16:31], v[48:51], v[144:147], 0
    v_mfma_f32_32x32x16_bf16 v[32:47], v[52:55], v[144:147], 0
    s_waitcnt vmcnt(3)
    v_mfma_f32_32x32x16_bf16 v[16:31], v[56:59], v[148:151], v[16:31]
    buffer_load_dwordx4 v[48:51], v3, s[16:19], s34 offen offset:1024 sc1
    v_mfma_f32_32x32x16_bf16 v[32:47], v[60:63], v[148:151], v[32:47]
    buffer_load_dwordx4 v[52:55], v3, s[16:19], s34 offen offset:2048 sc1
    s_waitcnt vmcnt(4)
    v_mfma_f32_32x32x16_bf16 v[16:31], v[64:67], v[152:155], v[16:31]
    buffer_load_dwordx4 v[56:59], v3, s[16:19], s34 offen offset:3072 sc1
    v_mfma_f32_32x32x16_bf16 v[32:47], v[68:71], v[152:155], v[32:47]
    buffer_load_dwordx4 v[60:63], v3, s[16:19], s35 offen offset:0 sc1
    s_waitcnt vmcnt(5)
    v_mfma_f32_32x32x16_bf16 v[16:31], v[72:75], v[156:159], v[16:31]
    buffer_load_dwordx4 v[64:67], v3, s[16:19], s35 offen offset:1024 sc1
    v_mfma_f32_32x32x16_bf16 v[32:47], v[76:79], v[156:159], v[32:47]
    buffer_load_dwordx4 v[68:71], v3, s[16:19], s35 offen offset:2048 sc1
    s_waitcnt vmcnt(6)
    v_mfma_f32_32x32x16_bf16 v[16:31], v[80:83], v[160:163], v[16:31]
    buffer_load_dwordx4 v[72:75], v3, s[16:19], s35 offen offset:3072 sc1
    v_mfma_f32_32x32x16_bf16 v[32:47], v[84:87], v[160:163], v[32:47]
    buffer_load_dwordx4 v[76:79], v3, s[16:19], s36 offen offset:0 sc1
    s_waitcnt vmcnt(7)
    v_mfma_f32_32x32x16_bf16 v[16:31], v[88:91], v[48:51], v[16:31]
    buffer_load_dwordx4 v[80:83], v3, s[16:19], s36 offen offset:1024 sc1
    v_mfma_f32_32x32x16_bf16 v[32:47], v[92:95], v[48:51], v[32:47]
    buffer_load_dwordx4 v[84:87], v3, s[16:19], s36 offen offset:2048 sc1
    s_waitcnt vmcnt(8)
    v_mfma_f32_32x32x16_bf16 v[16:31], v[96:99], v[52:55], v[16:31]
    buffer_load_dwordx4 v[88:91], v3, s[16:19], s36 offen offset:3072 sc1
    buffer_load_dwordx4 v[92:95], v3, s[16:19], s37 offen offset:0 sc1
    v_mfma_f32_32x32x16_bf16 v[32:47], v[100:103], v[52:55], v[32:47]
    buffer_load_dwordx4 v[48:51], v3, s[16:19], s37 offen offset:1024 sc1
    v_lshlrev_b32 v8, 4, v11
    v_add_u32 v8, 158720, v8
    ds_read_b128 v[152:155], v8
    v_sub_u32 v8, 95, v11
    v_cmp_gt_u32 vcc, 32, v11
    s_nop 1
    v_cndmask_b32 v8, v8, v11, vcc
    s_waitcnt vmcnt(10)
    v_mfma_f32_32x32x16_bf16 v[16:31], v[104:107], v[56:59], v[16:31]
    buffer_load_dwordx4 v[96:99], v3, s[16:19], s37 offen offset:2048 sc1
    buffer_load_dwordx4 v[100:103], v3, s[16:19], s37 offen offset:3072 sc1
    v_mfma_f32_32x32x16_bf16 v[32:47], v[108:111], v[56:59], v[32:47]
    buffer_load_dwordx4 v[52:55], v3, s[16:19], s38 offen offset:0 sc1
    v_lshlrev_b32 v8, 9, v8
    v_lshl_add_u32 v156, v6, 4, v8
    v_sub_u32 v8, 64, v11
    v_and_b32 v8, 31, v8
    v_add_u32 v8, 32, v8
    v_lshlrev_b32 v8, 9, v8
    ds_read_b32 v166, v0
    s_waitcnt vmcnt(12)
    v_mfma_f32_32x32x16_bf16 v[16:31], v[112:115], v[60:63], v[16:31]
    buffer_load_dwordx4 v[104:107], v3, s[16:19], s38 offen offset:1024 sc1
    v_mfma_f32_32x32x16_bf16 v[32:47], v[116:119], v[60:63], v[32:47]
    v_lshl_add_u32 v157, v6, 4, v8
    v_add_u32 v160, s48, v3
    v_add_u32 v161, s49, v3
    v_add_u32 v162, s50, v3
    v_add_u32 v163, s51, v3
    v_and_b32 v164, 3, v1
    s_waitcnt lgkmcnt(0)
    v_readfirstlane_b32 s56, v166
    s_add_u32 s31, s31, 1
    s_cmp_ge_u32 s56, s31
    s_cbranch_scc1 km_fuB9_ok
    s_mov_b32 s57, 0
km_fuB9:
    ds_read_b32 v9, v0 offset:0
    s_waitcnt lgkmcnt(0)
    v_readfirstlane_b32 s56, v9
    s_nop 0
    s_cmp_ge_u32 s56, s31
    s_cbranch_scc1 km_fuB9_ok
    s_sleep 1
    s_add_u32 s57, s57, 1
    s_cmp_lt_u32 s57, 2097152
    s_cbranch_scc1 km_fuB9
km_fuB9_ok:
    ds_read_b64_tr_b16 v[108:109], v14 offset:32768
    ds_read_b64_tr_b16 v[110:111], v14 offset:33280
    ds_read_b64_tr_b16 v[56:57], v15 offset:32768
    ds_read_b64_tr_b16 v[58:59], v15 offset:33280
    s_waitcnt vmcnt(12)
    v_mfma_f32_32x32x16_bf16 v[16:31], v[120:123], v[64:67], v[16:31]
    buffer_load_dwordx4 v[112:115], v3, s[16:19], s38 offen offset:2048 sc1
    v_mfma_f32_32x32x16_bf16 v[32:47], v[124:127], v[64:67], v[32:47]
    v_lshlrev_b32 v164, 2, v164
    v_bfe_u32 v8, v1, 2, 1
    v_lshl_add_u32 v164, v8, 5, v164
    v_add_u32 v164, 163408, v164
    ds_read_b64_tr_b16 v[116:117], v14 offset:34816
    ds_read_b64_tr_b16 v[118:119], v14 offset:35328
    ds_read_b64_tr_b16 v[60:61], v15 offset:34816
    ds_read_b64_tr_b16 v[62:63], v15 offset:35328
    s_waitcnt vmcnt(12)
    v_mfma_f32_32x32x16_bf16 v[16:31], v[128:131], v[68:71], v[16:31]
    buffer_load_dwordx4 v[120:123], v3, s[16:19], s38 offen offset:3072 sc1
    v_mfma_f32_32x32x16_bf16 v[32:47], v[132:135], v[68:71], v[32:47]
    ds_read_b64_tr_b16 v[124:125], v14 offset:36864
    ds_read_b64_tr_b16 v[126:127], v14 offset:37376
    ds_read_b64_tr_b16 v[64:65], v15 offset:36864
    ds_read_b64_tr_b16 v[66:67], v15 offset:37376
    s_waitcnt vmcnt(12)
    v_mfma_f32_32x32x16_bf16 v[16:31], v[136:139], v[72:75], v[16:31]
    buffer_load_dwordx4 v[128:131], v3, s[16:19], s39 offen offset:0 sc1
    v_mfma_f32_32x32x16_bf16 v[32:47], v[140:143], v[72:75], v[32:47]
    ds_read_b32 v166, v0
    ds_read_b64_tr_b16 v[132:133], v14 offset:38912
    ds_read_b64_tr_b16 v[134:135], v14 offset:39424
    ds_read_b64_tr_b16 v[68:69], v15 offset:38912
    ds_read_b64_tr_b16 v[70:71], v15 offset:39424
    s_waitcnt vmcnt(12)
    s_waitcnt lgkmcnt(13)
    v_mfma_f32_32x32x16_bf16 v[16:31], v[108:111], v[76:79], v[16:31]
    buffer_load_dwordx4 v[136:139], v3, s[16:19], s39 offen offset:1024 sc1
    v_mfma_f32_32x32x16_bf16 v[32:47], v[56:59], v[76:79], v[32:47]
    s_waitcnt lgkmcnt(4)
    v_readfirstlane_b32 s56, v166
    s_add_u32 s31, s31, 1
    s_cmp_ge_u32 s56, s31
    s_cbranch_scc1 km_fuB13_ok
    s_mov_b32 s57, 0
km_fuB13:
    ds_read_b32 v9, v0 offset:0
    s_waitcnt lgkmcnt(0)
    v_readfirstlane_b32 s56, v9
    s_nop 0
    s_cmp_ge_u32 s56, s31
    s_cbranch_scc1 km_fuB13_ok
    s_sleep 1
    s_add_u32 s57, s57, 1
    s_cmp_lt_u32 s57, 2097152
    s_cbranch_scc1 km_fuB13
km_fuB13_ok:
    ds_read_b64_tr_b16 v[140:141], v12 offset:0
    ds_read_b64_tr_b16 v[142:143], v12 offset:512
    ds_read_b64_tr_b16 v[72:73], v13 offset:0
    ds_read_b64_tr_b16 v[74:75], v13 offset:512
    s_waitcnt vmcnt(12)
    s_waitcnt lgkmcnt(13)
    v_mfma_f32_32x32x16_bf16 v[16:31], v[116:119], v[80:83], v[16:31]
    buffer_load_dwordx4 v[108:111], v3, s[16:19], s39 offen offset:2048 sc1
    v_mfma_f32_32x32x16_bf16 v[32:47], v[60:63], v[80:83], v[32:47]
    ds_read_b64_tr_b16 v[56:57], v12 offset:2048
    ds_read_b64_tr_b16 v[58:59], v12 offset:2560
    ds_read_b64_tr_b16 v[76:77], v13 offset:2048
    ds_read_b64_tr_b16 v[78:79], v13 offset:2560
    s_waitcnt vmcnt(12)
    s_waitcnt lgkmcnt(13)
    v_mfma_f32_32x32x16_bf16 v[16:31], v[124:127], v[84:87], v[16:31]
    buffer_load_dwordx4 v[116:119], v3, s[16:19], s39 offen offset:3072 sc1
    v_mfma_f32_32x32x16_bf16 v[32:47], v[64:67], v[84:87], v[32:47]
    buffer_load_dwordx4 v[144:147], v156, s[16:19], s45 offen sc1
    buffer_load_ushort v148, v157, s[16:19], s45 offen sc1
    ds_read_b64_tr_b16 v[60:61], v12 offset:4096
    ds_read_b64_tr_b16 v[62:63], v12 offset:4608
    ds_read_b64_tr_b16 v[80:81], v13 offset:4096
    ds_read_b64_tr_b16 v[82:83], v13 offset:4608
    s_waitcnt vmcnt(14)
    s_waitcnt lgkmcnt(12)
    v_mfma_f32_32x32x16_bf16 v[16:31], v[132:135], v[88:91], v[16:31]
    v_mfma_f32_32x32x16_bf16 v[32:47], v[68:71], v[88:91], v[32:47]
    s_mov_b64 exec, 1
    ds_add_u32 v10, v2 offset:16
    s_mov_b64 exec, -1
    ds_read_b32 v166, v0
    ds_read_b64_tr_b16 v[124:125], v12 offset:6144
    ds_read_b64_tr_b16 v[126:127], v12 offset:6656
    ds_read_b64_tr_b16 v[64:65], v13 offset:6144
    ds_read_b64_tr_b16 v[66:67], v13 offset:6656
    s_waitcnt vmcnt(13)
    s_waitcnt lgkmcnt(14)
    v_mfma_f32_32x32x16_bf16 v[16:31], v[140:143], v[92:95], v[16:31]
    v_mfma_f32_32x32x16_bf16 v[32:47], v[72:75], v[92:95], v[32:47]
    s_waitcnt lgkmcnt(4)
    v_readfirstlane_b32 s56, v166
    s_add_u32 s31, s31, 1
    s_cmp_ge_u32 s56, s31
    s_cbranch_scc1 km_fuB17_ok
    s_mov_b32 s57, 0
km_fuB17:
    ds_read_b32 v9, v0 offset:0
    s_waitcnt lgkmcnt(0)
    v_readfirstlane_b32 s56, v9
    s_nop 0
    s_cmp_ge_u32 s56, s31
    s_cbranch_scc1 km_fuB17_ok
    s_sleep 1
    s_add_u32 s57, s57, 1
    s_cmp_lt_u32 s57, 2097152
    s_cbranch_scc1 km_fuB17
km_fuB17_ok:
    ds_read_b64_tr_b16 v[84:85], v12 offset:32768
    ds_read_b64_tr_b16 v[86:87], v12 offset:33280
    ds_read_b64_tr_b16 v[132:133], v13 offset:32768
    ds_read_b64_tr_b16 v[134:135], v13 offset:33280
    s_waitcnt vmcnt(12)
    s_waitcnt lgkmcnt(14)
    v_mfma_f32_32x32x16_bf16 v[16:31], v[56:59], v[48:51], v[16:31]
    v_mfma_f32_32x32x16_bf16 v[32:47], v[76:79], v[48:51], v[32:47]
    ds_read_b64_tr_b16 v[68:69], v12 offset:34816
    ds_read_b64_tr_b16 v[70:71], v12 offset:35328
    ds_read_b64_tr_b16 v[88:89], v13 offset:34816
    ds_read_b64_tr_b16 v[90:91], v13 offset:35328
    s_waitcnt vmcnt(11)
    s_waitcnt lgkmcnt(14)
    v_mfma_f32_32x32x16_bf16 v[16:31], v[60:63], v[96:99], v[16:31]
    v_mfma_f32_32x32x16_bf16 v[32:47], v[80:83], v[96:99], v[32:47]
    ds_read_b64_tr_b16 v[140:141], v12 offset:36864
    ds_read_b64_tr_b16 v[142:143], v12 offset:37376
    ds_read_b64_tr_b16 v[72:73], v13 offset:36864
    ds_read_b64_tr_b16 v[74:75], v13 offset:37376
    s_waitcnt vmcnt(10)
    s_waitcnt lgkmcnt(12)
    v_mfma_f32_32x32x16_bf16 v[16:31], v[124:127], v[100:103], v[16:31]
    v_mfma_f32_32x32x16_bf16 v[32:47], v[64:67], v[100:103], v[32:47]
    ds_read_b32 v166, v0
    ds_read_b64_tr_b16 v[92:93], v12 offset:38912
    ds_read_b64_tr_b16 v[94:95], v12 offset:39424
    ds_read_b64_tr_b16 v[56:57], v13 offset:38912
    ds_read_b64_tr_b16 v[58:59], v13 offset:39424
    s_waitcnt vmcnt(9)
    s_waitcnt lgkmcnt(13)
    v_mfma_f32_32x32x16_bf16 v[16:31], v[84:87], v[52:55], v[16:31]
    v_mfma_f32_32x32x16_bf16 v[32:47], v[132:135], v[52:55], v[32:47]
    s_waitcnt lgkmcnt(4)
    v_readfirstlane_b32 s56, v166
    s_add_u32 s31, s31, 1
    s_cmp_ge_u32 s56, s31
    s_cbranch_scc1 km_fuB21_ok
    s_mov_b32 s57, 0
km_fuB21:
    ds_read_b32 v9, v0 offset:0
    s_waitcnt lgkmcnt(0)
    v_readfirstlane_b32 s56, v9
    s_nop 0
    s_cmp_ge_u32 s56, s31
    s_cbranch_scc1 km_fuB21_ok
    s_sleep 1
    s_add_u32 s57, s57, 1
    s_cmp_lt_u32 s57, 2097152
    s_cbranch_scc1 km_fuB21
km_fuB21_ok:
    ds_read_b64_tr_b16 v[76:77], v14 offset:0
    ds_read_b64_tr_b16 v[78:79], v14 offset:512
    ds_read_b64_tr_b16 v[48:49], v15 offset:0
    ds_read_b64_tr_b16 v[50:51], v15 offset:512
    s_waitcnt vmcnt(8)
    s_waitcnt lgkmcnt(13)
    v_mfma_f32_32x32x16_bf16 v[16:31], v[68:71], v[104:107], v[16:31]
    v_mfma_f32_32x32x16_bf16 v[32:47], v[88:91], v[104:107], v[32:47]
    ds_read_b64_tr_b16 v[60:61], v14 offset:2048
    ds_read_b64_tr_b16 v[62:63], v14 offset:2560
    ds_read_b64_tr_b16 v[80:81], v15 offset:2048
    ds_read_b64_tr_b16 v[82:83], v15 offset:2560
    s_waitcnt vmcnt(7)
    s_waitcnt lgkmcnt(13)
    v_mfma_f32_32x32x16_bf16 v[16:31], v[140:143], v[112:115], v[16:31]
    v_mfma_f32_32x32x16_bf16 v[32:47], v[72:75], v[112:115], v[32:47]
    ds_read_b64_tr_b16 v[96:97], v14 offset:4096
    ds_read_b64_tr_b16 v[98:99], v14 offset:4608
    ds_read_b64_tr_b16 v[124:125], v15 offset:4096
    ds_read_b64_tr_b16 v[126:127], v15 offset:4608
    s_waitcnt vmcnt(6)
    s_waitcnt lgkmcnt(12)
    v_mfma_f32_32x32x16_bf16 v[16:31], v[92:95], v[120:123], v[16:31]
    v_mfma_f32_32x32x16_bf16 v[32:47], v[56:59], v[120:123], v[32:47]
    ds_read_b64_tr_b16 v[64:65], v14 offset:6144
    ds_read_b64_tr_b16 v[66:67], v14 offset:6656
    ds_read_b64_tr_b16 v[100:101], v15 offset:6144
    ds_read_b64_tr_b16 v[102:103], v15 offset:6656
    s_waitcnt vmcnt(5)
    s_waitcnt lgkmcnt(12)
    v_mfma_f32_32x32x16_bf16 v[16:31], v[76:79], v[128:131], v[16:31]
    v_mfma_f32_32x32x16_bf16 v[32:47], v[48:51], v[128:131], v[32:47]
    ds_read_b32 v165, v164
    s_waitcnt vmcnt(4)
    s_waitcnt lgkmcnt(9)
    v_mfma_f32_32x32x16_bf16 v[16:31], v[60:63], v[136:139], v[16:31]
    v_mfma_f32_32x32x16_bf16 v[32:47], v[80:83], v[136:139], v[32:47]
    s_waitcnt vmcnt(3)
    s_waitcnt lgkmcnt(5)
    v_mfma_f32_32x32x16_bf16 v[16:31], v[96:99], v[108:111], v[16:31]
    v_mfma_f32_32x32x16_bf16 v[32:47], v[124:127], v[108:111], v[32:47]
    s_waitcnt vmcnt(2)
    s_waitcnt lgkmcnt(1)
    v_mfma_f32_32x32x16_bf16 v[16:31], v[64:67], v[116:119], v[16:31]
    v_mfma_f32_32x32x16_bf16 v[32:47], v[100:103], v[116:119], v[32:47]
km_djoin:
    s_waitcnt lgkmcnt(0)
    v_cmp_lt_u32 vcc, 3, v165
    s_nop 0
    s_cmp_eq_u64 vcc, -1
    s_cbranch_scc1 km_x_ok
    s_cmp_eq_u32 s27, 0
    s_cbranch_scc1 km_x_ok
    s_mov_b32 s57, 0
km_x_sp:
    ds_read_b32 v9, v164
    s_waitcnt lgkmcnt(0)
    v_cmp_lt_u32 vcc, 3, v9
    s_nop 0
    s_cmp_eq_u64 vcc, -1
    s_cbranch_scc1 km_x_ok
    s_sleep 1
    s_add_u32 s57, s57, 1
    s_cmp_lt_u32 s57, 2097152
    s_cbranch_scc1 km_x_sp
km_x_ok:
    s_nop 7
    ds_write_b128 v161, v[24:27] offset:0
    ds_write_b128 v161, v[28:31] offset:1024
    ds_write_b128 v162, v[32:35] offset:2048
    ds_write_b128 v162, v[36:39] offset:3072
    ds_write_b128 v163, v[40:43] offset:4096
    ds_write_b128 v163, v[44:47] offset:5120
    s_waitcnt vmcnt(0)
    v_lshlrev_b32 v72, 16, v152
    v_and_b32 v73, s46, v152
    v_lshlrev_b32 v74, 16, v153
    v_and_b32 v75, s46, v153
    v_lshlrev_b32 v76, 16, v154
    v_and_b32 v77, s46, v154
    v_lshlrev_b32 v78, 16, v155
    v_and_b32 v79, s46, v155
    s_cmp_ge_u32 s52, 4
    s_cbranch_scc1 km_up
    v_lshlrev_b32 v64, 16, v144
    v_and_b32 v65, s46, v144
    v_lshlrev_b32 v66, 16, v145
    v_and_b32 v67, s46, v145
    v_lshlrev_b32 v68, 16, v146
    v_and_b32 v69, s46, v146
    v_lshlrev_b32 v70, 16, v147
    v_and_b32 v71, s46, v147
    s_branch km_fin
km_up:
    v_lshlrev_b32 v64, 16, v148
    v_and_b32 v65, s46, v147
    v_lshlrev_b32 v66, 16, v147
    v_and_b32 v67, s46, v146
    v_lshlrev_b32 v68, 16, v146
    v_and_b32 v69, s46, v145
    v_lshlrev_b32 v70, 16, v145
    v_and_b32 v71, s46, v144
km_fin:
    s_waitcnt lgkmcnt(0)
    s_mov_b64 exec, 1
    ds_add_u32 v7, v2 offset:56
    s_mov_b64 exec, -1
    s_mov_b32 s57, 0
km_spinX1:
    ds_read_b32 v9, v7 offset:56
    s_waitcnt lgkmcnt(0)
    v_readfirstlane_b32 s56, v9
    s_nop 0
    s_cmp_ge_u32 s56, 4
    s_cbranch_scc1 km_spinX1_ok
    s_sleep 0
    s_add_u32 s57, s57, 1
    s_cmp_lt_u32 s57, 2097152
    s_cbranch_scc1 km_spinX1
km_spinX1_ok:
    ds_read_b128 v[80:83], v160 offset:0
    ds_read_b128 v[84:87], v160 offset:1024
    ds_read_b128 v[88:91], v160 offset:2048
    ds_read_b128 v[92:95], v160 offset:3072
    ds_read_b128 v[96:99], v160 offset:4096
    ds_read_b128 v[100:103], v160 offset:5120
    s_waitcnt lgkmcnt(4)
    v_pk_add_f32 v[16:17], v[16:17], v[80:81]
    v_pk_add_f32 v[18:19], v[18:19], v[82:83]
    v_pk_add_f32 v[20:21], v[20:21], v[84:85]
    v_pk_add_f32 v[22:23], v[22:23], v[86:87]
    s_waitcnt lgkmcnt(2)
    v_pk_add_f32 v[16:17], v[16:17], v[88:89]
    v_pk_add_f32 v[18:19], v[18:19], v[90:91]
    v_pk_add_f32 v[20:21], v[20:21], v[92:93]
    v_pk_add_f32 v[22:23], v[22:23], v[94:95]
    s_waitcnt lgkmcnt(0)
    v_pk_add_f32 v[16:17], v[16:17], v[96:97]
    v_pk_add_f32 v[18:19], v[18:19], v[98:99]
    v_pk_add_f32 v[20:21], v[20:21], v[100:101]
    v_pk_add_f32 v[22:23], v[22:23], v[102:103]
    v_fmac_f32 v64, v72, v16
    v_fmac_f32 v65, v73, v17
    v_fmac_f32 v66, v74, v18
    v_fmac_f32 v67, v75, v19
    v_fmac_f32 v68, v76, v20
    v_fmac_f32 v69, v77, v21
    v_fmac_f32 v70, v78, v22
    v_fmac_f32 v71, v79, v23
    v_cvt_pk_bf16_f32 v104, v64, v65
    v_cvt_pk_bf16_f32 v105, v66, v67
    v_cvt_pk_bf16_f32 v106, v68, v69
    v_cvt_pk_bf16_f32 v107, v70, v71
    buffer_store_dwordx4 v[104:107], v5, s[40:43], 0 offen
adaLN_cond__spectral_fnet__geglu_ffn__prompt_kernel_end:
adaLN_cond__spectral_fnet__geglu_ffn__prompt_kernel_exit:
    s_endpgm
.section .rodata,"a"
.p2align 6
.amdhsa_kernel adaLN_cond__spectral_fnet__geglu_ffn__prompt_kernel
  .amdhsa_next_free_vgpr 168
  .amdhsa_next_free_sgpr 100
  .amdhsa_accum_offset 168
  .amdhsa_group_segment_fixed_size 0
  .amdhsa_kernarg_size 112
  .amdhsa_user_sgpr_count 2
  .amdhsa_user_sgpr_kernarg_segment_ptr 1
  .amdhsa_system_sgpr_workgroup_id_x 1
.end_amdhsa_kernel
.text
```
